```python
import torch

def _softmax(x, axis=-1):
    return torch.softmax(x, dim=axis)

def _gelu(x):
    return torch.nn.functional.gelu(x, approximate='tanh')

def _silu(x):
    return torch.nn.functional.silu(x)

def _sigmoid(x):
    return torch.sigmoid(x)

def _layernorm(x, axis=-1, eps=1e-05):
    m = x.mean(dim=axis, keepdim=True)
    v = x.var(dim=axis, keepdim=True, unbiased=False)
    return (x - m) / torch.sqrt(v + eps)

def _scatter_add(tgt, idx, src, axis=0):
    return tgt.clone().index_add_(axis, idx, src)

def _segment_sum(src, seg, n):
    out = torch.zeros((n,) + src.shape[1:], dtype=src.dtype)
    return out.index_add_(0, seg, src)

def _pad(x, pw):
    flat = tuple((v for pair in reversed(pw) for v in pair))
    return torch.nn.functional.pad(x, flat)
kernel_name = 'sequential_preLN__memory_aug_recurrent_mem_tr__glu_gated_bilinear__prompt'

def setup_inputs():

    _w = lambda a: (lambda t: t.to(torch.bfloat16) if t.is_floating_point() else t)(torch.as_tensor(a))

    def _A_setup():
        B, S, Dm = (1, 2048, 512)
        H, Dh = (32, 128)
        M, seg = (8, 32)
        seg = min(seg, S)
        S = S // seg * seg
        return {'x': _w((lambda *s: torch.randn(*s, dtype=torch.bfloat16) * 0.05)(B, S, Dm)), 'mem0': _w((lambda *s: torch.randn(*s, dtype=torch.bfloat16) * 0.2)(B, M, Dm)), 'Wq': _w((lambda *s: torch.randn(*s, dtype=torch.bfloat16) * 1.6)(Dm, H, Dh) * Dm ** (-0.5)), 'Wk': _w((lambda *s: torch.randn(*s, dtype=torch.bfloat16) * 1.6)(Dm, H, Dh) * Dm ** (-0.5)), 'Wv': _w((lambda *s: torch.randn(*s, dtype=torch.bfloat16) * 0.2)(Dm, H, Dh) * Dm ** (-0.5)), 'Wo': _w((lambda *s: torch.randn(*s, dtype=torch.bfloat16) * 0.2)(H, Dh, Dm) * (H * Dh) ** (-0.5)), 'seg_len': seg}
    _A_in = _A_setup()

    def _B_setup():
        B, S, D, F = (1, 2048, 512, 1792)
        return {'x': _w((lambda *s: torch.randn(*s, dtype=torch.bfloat16) * 0.05)(B, S, D)), 'w_gate': _w((lambda *s: torch.randn(*s, dtype=torch.bfloat16) * 0.2)(D, F) * D ** (-0.5)), 'w_up': _w((lambda *s: torch.randn(*s, dtype=torch.bfloat16) * 0.2)(D, F) * D ** (-0.5)), 'w_down': _w((lambda *s: torch.randn(*s, dtype=torch.bfloat16) * 0.2)(F, D) * F ** (-0.5))}
    _B_in = _B_setup()
    return {'A_x': _A_in['x'], 'A_mem0': _A_in['mem0'], 'A_Wq': _A_in['Wq'], 'A_Wk': _A_in['Wk'], 'A_Wv': _A_in['Wv'], 'A_Wo': _A_in['Wo'], 'A_seg_len': _A_in['seg_len'], 'B_x': _B_in['x'], 'B_w_gate': _B_in['w_gate'], 'B_w_up': _B_in['w_up'], 'B_w_down': _B_in['w_down']}

def reference(A_x, A_mem0, A_Wq, A_Wk, A_Wv, A_Wo, A_seg_len, B_x, B_w_gate, B_w_up, B_w_down):

    def _A_ref(x, mem0, Wq, Wk, Wv, Wo, seg_len):
        B, S, Dm = x.shape
        H, Dh = (Wq.shape[1], Wq.shape[2])
        M = mem0.shape[1]
        scale = Dh ** (-0.5)
        n_seg = S // seg_len
        L = M + seg_len
        idx = torch.arange(L)
        mask = (idx[:, None] < M) | (idx[:, None] >= idx[None, :])
        mem = mem0
        outs = []
        for s in range(n_seg):
            xs = x[:, s * seg_len:(s + 1) * seg_len, :].clone()
            h = torch.concatenate([mem, xs], axis=1)
            q = torch.einsum('btd,dhe->bhte', h, Wq)
            k = torch.einsum('btd,dhe->bhte', h, Wk)
            v = torch.einsum('btd,dhe->bhte', h, Wv)
            scores = torch.einsum('bhqe,bhke->bhqk', q, k) * scale
            scores = torch.where(mask[None, None], scores, -1000000000.0)
            p = _softmax(scores, axis=-1)
            o = torch.einsum('bhqk,bhke->bhqe', p, v)
            o = torch.einsum('bhte,hed->btd', o, Wo)
            mem = o[:, :M, :].clone()
            outs.append(o[:, M:, :])
        return torch.concatenate(outs, axis=1)

    def _B_ref(x, w_gate, w_up, w_down):
        g = torch.einsum('bsd,df->bsf', x, w_gate)
        u = torch.einsum('bsd,df->bsf', x, w_up)
        h = g * u
        return torch.einsum('bsf,fd->bsd', h, w_down)
    x = A_x
    h = x + _A_ref(_layernorm(x, axis=-1), A_mem0, A_Wq, A_Wk, A_Wv, A_Wo, A_seg_len)
    h2 = h + _B_ref(_layernorm(h, axis=-1), B_w_gate, B_w_up, B_w_down)
    return h2
```

```asm
; @launch kernel=prep_kernel grid=(8036,1,1) block=(256,1,1) lds=0
; @launch kernel=mega_kernel grid=(256,1,1) block=(512,1,1) lds=163840
.amdgcn_target "amdgcn-amd-amdhsa--gfx950"
.text
.globl prep_kernel
.p2align 8
.type prep_kernel,@function
prep_kernel:
    s_load_dwordx2 s[4:5], s[0:1], 104
    s_load_dwordx2 s[6:7], s[0:1], 0
    v_and_b32 v1, 63, v0
    v_lshrrev_b32 v4, 6, v0
    s_waitcnt lgkmcnt(0)

    s_mov_b32 s8, s4
    s_and_b32 s9, s5, 0xffff
    s_mov_b32 s10, 0x10000000
    s_mov_b32 s11, 0x00020000
    s_mov_b32 s12, s6
    s_and_b32 s13, s7, 0xffff
    s_mov_b32 s14, 0x200000
    s_mov_b32 s15, 0x00020000
    s_cmp_ge_u32 s2, 512
    s_cbranch_scc1 .L1
    s_lshl_b32 s3, s2, 2
    v_add_u32 v4, s3, v4
    v_lshlrev_b32 v2, 10, v4
    v_lshl_add_u32 v2, v1, 4, v2
    v_add_u32 v3, 0x0, v2
    buffer_load_dwordx4 v[8:11], v3, s[12:15], 0 offen
    s_waitcnt vmcnt(0)

    v_lshlrev_b32 v12, 16, v8
    v_and_b32 v13, 0xffff0000, v8
    v_lshlrev_b32 v14, 16, v9
    v_and_b32 v15, 0xffff0000, v9
    v_lshlrev_b32 v16, 16, v10
    v_and_b32 v17, 0xffff0000, v10
    v_lshlrev_b32 v18, 16, v11
    v_and_b32 v19, 0xffff0000, v11
    v_add_f32 v20, v12, v13
    v_add_f32 v20, v20, v14
    v_add_f32 v20, v20, v15
    v_add_f32 v20, v20, v16
    v_add_f32 v20, v20, v17
    v_add_f32 v20, v20, v18
    v_add_f32 v20, v20, v19
    s_nop 1
    v_add_f32_dpp v21, v20, v20 row_ror:8 row_mask:0xf bank_mask:0xf
    s_nop 1
    v_mov_b32 v20, v21
    s_nop 1
    v_add_f32_dpp v21, v20, v20 row_ror:4 row_mask:0xf bank_mask:0xf
    s_nop 1
    v_mov_b32 v20, v21
    s_nop 1
    v_add_f32_dpp v21, v20, v20 row_ror:2 row_mask:0xf bank_mask:0xf
    s_nop 1
    v_mov_b32 v20, v21
    s_nop 1
    v_add_f32_dpp v21, v20, v20 row_ror:1 row_mask:0xf bank_mask:0xf
    s_nop 1
    v_mov_b32 v20, v21
    v_mov_b32 v21, v20
    s_nop 1
    v_permlane16_swap_b32 v20, v21
    s_nop 1
    v_add_f32 v20, v20, v21
    v_mov_b32 v21, v20
    s_nop 1
    v_permlane32_swap_b32 v20, v21
    s_nop 1
    v_add_f32 v20, v20, v21
    v_mul_f32 v20, 0x3b000000, v20
    v_sub_f32 v22, v12, v20
    v_sub_f32 v23, v13, v20
    v_sub_f32 v24, v14, v20
    v_sub_f32 v25, v15, v20
    v_sub_f32 v26, v16, v20
    v_sub_f32 v27, v17, v20
    v_sub_f32 v28, v18, v20
    v_sub_f32 v29, v19, v20
    v_mul_f32 v30, v22, v22
    v_fmac_f32 v30, v23, v23
    v_fmac_f32 v30, v24, v24
    v_fmac_f32 v30, v25, v25
    v_fmac_f32 v30, v26, v26
    v_fmac_f32 v30, v27, v27
    v_fmac_f32 v30, v28, v28
    v_fmac_f32 v30, v29, v29
    s_nop 1
    v_add_f32_dpp v21, v30, v30 row_ror:8 row_mask:0xf bank_mask:0xf
    s_nop 1
    v_mov_b32 v30, v21
    s_nop 1
    v_add_f32_dpp v21, v30, v30 row_ror:4 row_mask:0xf bank_mask:0xf
    s_nop 1
    v_mov_b32 v30, v21
    s_nop 1
    v_add_f32_dpp v21, v30, v30 row_ror:2 row_mask:0xf bank_mask:0xf
    s_nop 1
    v_mov_b32 v30, v21
    s_nop 1
    v_add_f32_dpp v21, v30, v30 row_ror:1 row_mask:0xf bank_mask:0xf
    s_nop 1
    v_mov_b32 v30, v21
    v_mov_b32 v21, v30
    s_nop 1
    v_permlane16_swap_b32 v30, v21
    s_nop 1
    v_add_f32 v30, v30, v21
    v_mov_b32 v21, v30
    s_nop 1
    v_permlane32_swap_b32 v30, v21
    s_nop 1
    v_add_f32 v30, v30, v21
    v_mul_f32 v30, 0x3b000000, v30
    v_cvt_pk_bf16_f32 v31, v20, v30
    v_lshlrev_b32 v20, 16, v31
    v_and_b32 v30, 0xffff0000, v31
    v_add_f32 v30, 0x3727c5ac, v30
    v_cvt_pk_bf16_f32 v31, v30, v30
    v_and_b32 v30, 0xffff0000, v31
    v_sqrt_f32 v30, v30
    s_nop 0
    v_cvt_pk_bf16_f32 v31, v30, v30
    v_and_b32 v30, 0xffff0000, v31
    v_rcp_f32 v30, v30
    s_nop 0
    v_sub_f32 v22, v12, v20
    v_sub_f32 v23, v13, v20
    v_sub_f32 v24, v14, v20
    v_sub_f32 v25, v15, v20
    v_sub_f32 v26, v16, v20
    v_sub_f32 v27, v17, v20
    v_sub_f32 v28, v18, v20
    v_sub_f32 v29, v19, v20
    v_cvt_pk_bf16_f32 v8, v22, v23
    v_cvt_pk_bf16_f32 v9, v24, v25
    v_cvt_pk_bf16_f32 v10, v26, v27
    v_cvt_pk_bf16_f32 v11, v28, v29
    v_lshlrev_b32 v12, 16, v8
    v_and_b32 v13, 0xffff0000, v8
    v_lshlrev_b32 v14, 16, v9
    v_and_b32 v15, 0xffff0000, v9
    v_lshlrev_b32 v16, 16, v10
    v_and_b32 v17, 0xffff0000, v10
    v_lshlrev_b32 v18, 16, v11
    v_and_b32 v19, 0xffff0000, v11
    v_mul_f32 v12, v12, v30
    v_mul_f32 v13, v13, v30
    v_mul_f32 v14, v14, v30
    v_mul_f32 v15, v15, v30
    v_mul_f32 v16, v16, v30
    v_mul_f32 v17, v17, v30
    v_mul_f32 v18, v18, v30
    v_mul_f32 v19, v19, v30
    v_cvt_pk_bf16_f32 v8, v12, v13
    v_cvt_pk_bf16_f32 v9, v14, v15
    v_cvt_pk_bf16_f32 v10, v16, v17
    v_cvt_pk_bf16_f32 v11, v18, v19
    v_add_u32 v3, 0x0, v2
    buffer_store_dwordx4 v[8:11], v3, s[8:11], 0 offen
    s_endpgm
.L1:
    s_cmp_ge_u32 s2, 1536
    s_cbranch_scc1 .L2
    s_load_dwordx2 s[6:7], s[0:1], 16
    s_sub_u32 s3, s2, 512
    s_lshl_b32 s3, s3, 8
    v_add_u32 v2, s3, v0
    s_waitcnt lgkmcnt(0)
    s_mov_b32 s16, s6
    s_and_b32 s17, s7, 0xffff
    s_mov_b32 s18, 0x400000
    s_mov_b32 s19, 0x00020000
    v_lshrrev_b32 v3, 6, v2
    v_and_b32 v5, 15, v3
    v_lshrrev_b32 v6, 4, v3
    v_and_b32 v7, 15, v1
    v_lshl_add_u32 v6, v6, 4, v7
    v_lshrrev_b32 v7, 4, v1
    v_lshlrev_b32 v7, 3, v7
    v_lshl_add_u32 v5, v5, 5, v7
    s_mov_b32 s3, 8192
    v_mul_lo_u32 v5, v5, s3
    v_lshl_add_u32 v5, v6, 1, v5
    buffer_load_ushort v8, v5, s[16:19], 0 offen
    v_add_u32 v5, 8192, v5
    buffer_load_ushort v9, v5, s[16:19], 0 offen
    v_add_u32 v5, 8192, v5
    buffer_load_ushort v10, v5, s[16:19], 0 offen
    v_add_u32 v5, 8192, v5
    buffer_load_ushort v11, v5, s[16:19], 0 offen
    v_add_u32 v5, 8192, v5
    buffer_load_ushort v12, v5, s[16:19], 0 offen
    v_add_u32 v5, 8192, v5
    buffer_load_ushort v13, v5, s[16:19], 0 offen
    v_add_u32 v5, 8192, v5
    buffer_load_ushort v14, v5, s[16:19], 0 offen
    v_add_u32 v5, 8192, v5
    buffer_load_ushort v15, v5, s[16:19], 0 offen
    s_waitcnt vmcnt(0)
    v_lshl_or_b32 v16, v9, 16, v8
    v_lshl_or_b32 v17, v11, 16, v10
    v_lshl_or_b32 v18, v13, 16, v12
    v_lshl_or_b32 v19, v15, 16, v14
    v_lshlrev_b32 v2, 4, v2
    v_add_u32 v2, 0x200000, v2
    buffer_store_dwordx4 v[16:19], v2, s[8:11], 0 offen
    s_endpgm
.L2:
    s_cmp_ge_u32 s2, 2560
    s_cbranch_scc1 .L3
    s_load_dwordx2 s[6:7], s[0:1], 24
    s_sub_u32 s3, s2, 1536
    s_lshl_b32 s3, s3, 8
    v_add_u32 v2, s3, v0
    s_waitcnt lgkmcnt(0)
    s_mov_b32 s16, s6
    s_and_b32 s17, s7, 0xffff
    s_mov_b32 s18, 0x400000
    s_mov_b32 s19, 0x00020000
    v_lshrrev_b32 v3, 6, v2
    v_and_b32 v5, 15, v3
    v_lshrrev_b32 v6, 4, v3
    v_and_b32 v7, 15, v1
    v_lshl_add_u32 v6, v6, 4, v7
    v_lshrrev_b32 v7, 4, v1
    v_lshlrev_b32 v7, 3, v7
    v_lshl_add_u32 v5, v5, 5, v7
    s_mov_b32 s3, 8192
    v_mul_lo_u32 v5, v5, s3
    v_lshl_add_u32 v5, v6, 1, v5
    buffer_load_ushort v8, v5, s[16:19], 0 offen
    v_add_u32 v5, 8192, v5
    buffer_load_ushort v9, v5, s[16:19], 0 offen
    v_add_u32 v5, 8192, v5
    buffer_load_ushort v10, v5, s[16:19], 0 offen
    v_add_u32 v5, 8192, v5
    buffer_load_ushort v11, v5, s[16:19], 0 offen
    v_add_u32 v5, 8192, v5
    buffer_load_ushort v12, v5, s[16:19], 0 offen
    v_add_u32 v5, 8192, v5
    buffer_load_ushort v13, v5, s[16:19], 0 offen
    v_add_u32 v5, 8192, v5
    buffer_load_ushort v14, v5, s[16:19], 0 offen
    v_add_u32 v5, 8192, v5
    buffer_load_ushort v15, v5, s[16:19], 0 offen
    s_waitcnt vmcnt(0)
    v_lshl_or_b32 v16, v9, 16, v8
    v_lshl_or_b32 v17, v11, 16, v10
    v_lshl_or_b32 v18, v13, 16, v12
    v_lshl_or_b32 v19, v15, 16, v14
    v_lshlrev_b32 v2, 4, v2
    v_add_u32 v2, 0x600000, v2
    buffer_store_dwordx4 v[16:19], v2, s[8:11], 0 offen
    s_endpgm
.L3:
    s_cmp_ge_u32 s2, 3584
    s_cbranch_scc1 .L4
    s_load_dwordx2 s[6:7], s[0:1], 32
    s_sub_u32 s3, s2, 2560
    s_lshl_b32 s3, s3, 8
    v_add_u32 v2, s3, v0
    s_waitcnt lgkmcnt(0)
    s_mov_b32 s16, s6
    s_and_b32 s17, s7, 0xffff
    s_mov_b32 s18, 0x400000
    s_mov_b32 s19, 0x00020000
    v_lshrrev_b32 v3, 6, v2
    v_and_b32 v5, 15, v3
    v_lshrrev_b32 v6, 4, v3
    v_and_b32 v7, 15, v1
    v_lshl_add_u32 v6, v6, 4, v7
    v_lshrrev_b32 v7, 4, v1
    v_lshlrev_b32 v7, 3, v7
    v_lshl_add_u32 v5, v5, 5, v7
    s_mov_b32 s3, 8192
    v_mul_lo_u32 v5, v5, s3
    v_lshl_add_u32 v5, v6, 1, v5
    buffer_load_ushort v8, v5, s[16:19], 0 offen
    v_add_u32 v5, 8192, v5
    buffer_load_ushort v9, v5, s[16:19], 0 offen
    v_add_u32 v5, 8192, v5
    buffer_load_ushort v10, v5, s[16:19], 0 offen
    v_add_u32 v5, 8192, v5
    buffer_load_ushort v11, v5, s[16:19], 0 offen
    v_add_u32 v5, 8192, v5
    buffer_load_ushort v12, v5, s[16:19], 0 offen
    v_add_u32 v5, 8192, v5
    buffer_load_ushort v13, v5, s[16:19], 0 offen
    v_add_u32 v5, 8192, v5
    buffer_load_ushort v14, v5, s[16:19], 0 offen
    v_add_u32 v5, 8192, v5
    buffer_load_ushort v15, v5, s[16:19], 0 offen
    s_waitcnt vmcnt(0)
    v_lshl_or_b32 v16, v9, 16, v8
    v_lshl_or_b32 v17, v11, 16, v10
    v_lshl_or_b32 v18, v13, 16, v12
    v_lshl_or_b32 v19, v15, 16, v14
    v_lshlrev_b32 v2, 4, v2
    v_add_u32 v2, 0xa00000, v2
    buffer_store_dwordx4 v[16:19], v2, s[8:11], 0 offen
    s_endpgm
.L4:
    s_cmp_ge_u32 s2, 4608
    s_cbranch_scc1 .L5
    s_load_dwordx2 s[6:7], s[0:1], 40
    s_sub_u32 s3, s2, 3584
    s_lshl_b32 s3, s3, 8
    v_add_u32 v2, s3, v0
    s_waitcnt lgkmcnt(0)
    s_mov_b32 s16, s6
    s_and_b32 s17, s7, 0xffff
    s_mov_b32 s18, 0x400000
    s_mov_b32 s19, 0x00020000
    v_lshrrev_b32 v3, 6, v2
    v_and_b32 v5, 127, v3
    v_lshrrev_b32 v6, 7, v3
    v_and_b32 v7, 15, v1
    v_lshl_add_u32 v6, v6, 4, v7
    v_lshrrev_b32 v7, 4, v1
    v_lshlrev_b32 v7, 3, v7
    v_lshl_add_u32 v5, v5, 5, v7
    s_mov_b32 s3, 1024
    v_mul_lo_u32 v5, v5, s3
    v_lshl_add_u32 v5, v6, 1, v5
    buffer_load_ushort v8, v5, s[16:19], 0 offen
    v_add_u32 v5, 1024, v5
    buffer_load_ushort v9, v5, s[16:19], 0 offen
    v_add_u32 v5, 1024, v5
    buffer_load_ushort v10, v5, s[16:19], 0 offen
    v_add_u32 v5, 1024, v5
    buffer_load_ushort v11, v5, s[16:19], 0 offen
    v_add_u32 v5, 1024, v5
    buffer_load_ushort v12, v5, s[16:19], 0 offen
    v_add_u32 v5, 1024, v5
    buffer_load_ushort v13, v5, s[16:19], 0 offen
    v_add_u32 v5, 1024, v5
    buffer_load_ushort v14, v5, s[16:19], 0 offen
    v_add_u32 v5, 1024, v5
    buffer_load_ushort v15, v5, s[16:19], 0 offen
    s_waitcnt vmcnt(0)
    v_lshl_or_b32 v16, v9, 16, v8
    v_lshl_or_b32 v17, v11, 16, v10
    v_lshl_or_b32 v18, v13, 16, v12
    v_lshl_or_b32 v19, v15, 16, v14
    v_lshlrev_b32 v2, 4, v2
    v_add_u32 v2, 0xe00000, v2
    buffer_store_dwordx4 v[16:19], v2, s[8:11], 0 offen
    s_endpgm
.L5:
    s_cmp_ge_u32 s2, 5056
    s_cbranch_scc1 .L6
    s_load_dwordx2 s[6:7], s[0:1], 64
    s_sub_u32 s3, s2, 4608
    s_lshl_b32 s3, s3, 8
    v_add_u32 v2, s3, v0
    s_waitcnt lgkmcnt(0)
    s_mov_b32 s16, s6
    s_and_b32 s17, s7, 0xffff
    s_mov_b32 s18, 0x1c0000
    s_mov_b32 s19, 0x00020000
    v_lshrrev_b32 v3, 6, v2
    v_and_b32 v5, 15, v3
    v_lshrrev_b32 v6, 4, v3
    v_and_b32 v7, 15, v1
    v_lshl_add_u32 v6, v6, 4, v7
    v_lshrrev_b32 v7, 4, v1
    v_lshlrev_b32 v7, 3, v7
    v_lshl_add_u32 v5, v5, 5, v7
    s_mov_b32 s3, 3584
    v_mul_lo_u32 v5, v5, s3
    v_lshl_add_u32 v5, v6, 1, v5
    buffer_load_ushort v8, v5, s[16:19], 0 offen
    v_add_u32 v5, 3584, v5
    buffer_load_ushort v9, v5, s[16:19], 0 offen
    v_add_u32 v5, 3584, v5
    buffer_load_ushort v10, v5, s[16:19], 0 offen
    v_add_u32 v5, 3584, v5
    buffer_load_ushort v11, v5, s[16:19], 0 offen
    v_add_u32 v5, 3584, v5
    buffer_load_ushort v12, v5, s[16:19], 0 offen
    v_add_u32 v5, 3584, v5
    buffer_load_ushort v13, v5, s[16:19], 0 offen
    v_add_u32 v5, 3584, v5
    buffer_load_ushort v14, v5, s[16:19], 0 offen
    v_add_u32 v5, 3584, v5
    buffer_load_ushort v15, v5, s[16:19], 0 offen
    s_waitcnt vmcnt(0)
    v_lshl_or_b32 v16, v9, 16, v8
    v_lshl_or_b32 v17, v11, 16, v10
    v_lshl_or_b32 v18, v13, 16, v12
    v_lshl_or_b32 v19, v15, 16, v14
    v_lshlrev_b32 v2, 4, v2
    v_add_u32 v2, 0x1200000, v2
    buffer_store_dwordx4 v[16:19], v2, s[8:11], 0 offen
    s_endpgm
.L6:
    s_cmp_ge_u32 s2, 5504
    s_cbranch_scc1 .L7
    s_load_dwordx2 s[6:7], s[0:1], 72
    s_sub_u32 s3, s2, 5056
    s_lshl_b32 s3, s3, 8
    v_add_u32 v2, s3, v0
    s_waitcnt lgkmcnt(0)
    s_mov_b32 s16, s6
    s_and_b32 s17, s7, 0xffff
    s_mov_b32 s18, 0x1c0000
    s_mov_b32 s19, 0x00020000
    v_lshrrev_b32 v3, 6, v2
    v_and_b32 v5, 15, v3
    v_lshrrev_b32 v6, 4, v3
    v_and_b32 v7, 15, v1
    v_lshl_add_u32 v6, v6, 4, v7
    v_lshrrev_b32 v7, 4, v1
    v_lshlrev_b32 v7, 3, v7
    v_lshl_add_u32 v5, v5, 5, v7
    s_mov_b32 s3, 3584
    v_mul_lo_u32 v5, v5, s3
    v_lshl_add_u32 v5, v6, 1, v5
    buffer_load_ushort v8, v5, s[16:19], 0 offen
    v_add_u32 v5, 3584, v5
    buffer_load_ushort v9, v5, s[16:19], 0 offen
    v_add_u32 v5, 3584, v5
    buffer_load_ushort v10, v5, s[16:19], 0 offen
    v_add_u32 v5, 3584, v5
    buffer_load_ushort v11, v5, s[16:19], 0 offen
    v_add_u32 v5, 3584, v5
    buffer_load_ushort v12, v5, s[16:19], 0 offen
    v_add_u32 v5, 3584, v5
    buffer_load_ushort v13, v5, s[16:19], 0 offen
    v_add_u32 v5, 3584, v5
    buffer_load_ushort v14, v5, s[16:19], 0 offen
    v_add_u32 v5, 3584, v5
    buffer_load_ushort v15, v5, s[16:19], 0 offen
    s_waitcnt vmcnt(0)
    v_lshl_or_b32 v16, v9, 16, v8
    v_lshl_or_b32 v17, v11, 16, v10
    v_lshl_or_b32 v18, v13, 16, v12
    v_lshl_or_b32 v19, v15, 16, v14
    v_lshlrev_b32 v2, 4, v2
    v_add_u32 v2, 0x1400000, v2
    buffer_store_dwordx4 v[16:19], v2, s[8:11], 0 offen
    s_endpgm
.L7:
    s_cmp_ge_u32 s2, 5952
    s_cbranch_scc1 .L8
    s_load_dwordx2 s[6:7], s[0:1], 80
    s_sub_u32 s3, s2, 5504
    s_lshl_b32 s3, s3, 8
    v_add_u32 v2, s3, v0
    s_waitcnt lgkmcnt(0)
    s_mov_b32 s16, s6
    s_and_b32 s17, s7, 0xffff
    s_mov_b32 s18, 0x1c0000
    s_mov_b32 s19, 0x00020000
    v_lshrrev_b32 v3, 6, v2
    v_and_b32 v6, 31, v3
    v_lshrrev_b32 v5, 5, v3
    v_and_b32 v7, 15, v1
    v_lshl_add_u32 v6, v6, 4, v7
    v_lshrrev_b32 v7, 4, v1
    v_lshlrev_b32 v7, 3, v7
    v_lshl_add_u32 v5, v5, 5, v7
    s_mov_b32 s3, 1024
    v_mul_lo_u32 v5, v5, s3
    v_lshl_add_u32 v5, v6, 1, v5
    buffer_load_ushort v8, v5, s[16:19], 0 offen
    v_add_u32 v5, 1024, v5
    buffer_load_ushort v9, v5, s[16:19], 0 offen
    v_add_u32 v5, 1024, v5
    buffer_load_ushort v10, v5, s[16:19], 0 offen
    v_add_u32 v5, 1024, v5
    buffer_load_ushort v11, v5, s[16:19], 0 offen
    v_add_u32 v5, 1024, v5
    buffer_load_ushort v12, v5, s[16:19], 0 offen
    v_add_u32 v5, 1024, v5
    buffer_load_ushort v13, v5, s[16:19], 0 offen
    v_add_u32 v5, 1024, v5
    buffer_load_ushort v14, v5, s[16:19], 0 offen
    v_add_u32 v5, 1024, v5
    buffer_load_ushort v15, v5, s[16:19], 0 offen
    s_waitcnt vmcnt(0)
    v_lshl_or_b32 v16, v9, 16, v8
    v_lshl_or_b32 v17, v11, 16, v10
    v_lshl_or_b32 v18, v13, 16, v12
    v_lshl_or_b32 v19, v15, 16, v14
    v_lshlrev_b32 v2, 4, v2
    v_add_u32 v2, 0x1600000, v2
    buffer_store_dwordx4 v[16:19], v2, s[8:11], 0 offen
    s_endpgm
.L8:
    s_cmp_ge_u32 s2, 8032
    s_cbranch_scc1 .L9
    s_sub_u32 s3, s2, 5952
    s_lshl_b32 s3, s3, 14
    s_cmp_ge_u32 s3, 0x2000000
    s_mov_b32 s17, 0x8000000
    s_cselect_b32 s16, 0x5002000, s17
    s_add_u32 s3, s3, s16
    v_lshl_add_u32 v2, v0, 4, s3
    v_mov_b32 v8, -1
    v_mov_b32 v9, -1
    v_mov_b32 v10, -1
    v_mov_b32 v11, -1
    buffer_store_dwordx4 v[8:11], v2, s[8:11], 0 offen offset:0
    v_add_u32 v2, 0x1000, v2
    buffer_store_dwordx4 v[8:11], v2, s[8:11], 0 offen offset:0
    v_add_u32 v2, 0x1000, v2
    buffer_store_dwordx4 v[8:11], v2, s[8:11], 0 offen offset:0
    v_add_u32 v2, 0x1000, v2
    buffer_store_dwordx4 v[8:11], v2, s[8:11], 0 offen offset:0
    s_endpgm
.L9:
    s_cmp_ge_u32 s2, 8034
    s_cbranch_scc1 .L10
    s_load_dwordx2 s[6:7], s[0:1], 8
    s_sub_u32 s3, s2, 8032
    s_lshl_b32 s3, s3, 8
    v_add_u32 v2, s3, v0
    s_waitcnt lgkmcnt(0)
    s_mov_b32 s16, s6
    s_and_b32 s17, s7, 0xffff
    s_mov_b32 s18, 0x2000
    s_mov_b32 s19, 0x00020000
    v_and_b32 v3, 7, v2
    v_lshrrev_b32 v5, 3, v2
    v_lshlrev_b32 v3, 10, v3
    v_lshl_add_u32 v3, v5, 4, v3
    buffer_load_dwordx4 v[8:11], v3, s[16:19], 0 offen
    v_lshlrev_b32 v2, 4, v2
    v_add_u32 v2, 0x7000000, v2
    s_waitcnt vmcnt(0)
    v_min_u32 v8, -2, v8
    v_min_u32 v9, -2, v9
    v_min_u32 v10, -2, v10
    v_min_u32 v11, -2, v11
    buffer_store_dwordx4 v[8:11], v2, s[8:11], 0 offen
    s_endpgm
.L10:
    s_cmp_ge_u32 s2, 8036
    s_cbranch_scc1 .L11
    s_sub_u32 s3, s2, 8034
    s_lshl_b32 s3, s3, 14
    s_add_u32 s3, s3, 0x7100000
    v_lshl_add_u32 v2, v0, 4, s3
    v_mov_b32 v8, 0
    v_mov_b32 v9, 0
    v_mov_b32 v10, 0
    v_mov_b32 v11, 0
    buffer_store_dwordx4 v[8:11], v2, s[8:11], 0 offen
    v_add_u32 v2, 0x1000, v2
    buffer_store_dwordx4 v[8:11], v2, s[8:11], 0 offen
    v_add_u32 v2, 0x1000, v2
    buffer_store_dwordx4 v[8:11], v2, s[8:11], 0 offen
    v_add_u32 v2, 0x1000, v2
    buffer_store_dwordx4 v[8:11], v2, s[8:11], 0 offen
.L11:
    s_endpgm
.globl mega_kernel
.p2align 8
.type mega_kernel,@function
mega_kernel:
    s_cmp_ge_u32 s2, 256
    s_cbranch_scc1 .mexit14
    s_load_dwordx2 s[4:5], s[0:1], 104
    s_load_dwordx2 s[6:7], s[0:1], 0
    s_load_dwordx2 s[22:23], s[0:1], 88
    v_and_b32 v1, 63, v0
    v_lshrrev_b32 v2, 6, v0
    s_nop 0
    v_readfirstlane_b32 s20, v2
    s_waitcnt lgkmcnt(0)

    s_mov_b32 s8, s4
    s_and_b32 s9, s5, 0xffff
    s_mov_b32 s10, 0x10000000
    s_mov_b32 s11, 0x00020000
    s_mov_b32 s12, s6
    s_and_b32 s13, s7, 0xffff
    s_mov_b32 s14, 0x200000
    s_mov_b32 s15, 0x00020000
    s_mov_b32 s16, s22
    s_and_b32 s17, s23, 0xffff
    s_mov_b32 s18, 0x200000
    s_mov_b32 s19, 0x00020000
    s_and_b32 s3, s2, 7
    s_lshr_b32 s21, s2, 3
    s_cmp_lg_u32 s3, 0
    s_cbranch_scc1 .mwk13
    s_mov_b32 s2, s21

    v_and_b32 v2, 15, v1
    v_lshrrev_b32 v3, 4, v1
    v_and_b32 v18, 7, v1

    s_getreg_b32 s21, hwreg(HW_REG_XCC_ID)
    s_add_u32 s21, s21, 1
    s_lshl_b32 s22, s2, 2
    s_add_u32 s22, s22, 0x7106000
    v_mov_b32 v20, s22
    v_mov_b32 v21, s21
    s_mov_b64 exec, 1
    buffer_store_dword v21, v20, s[8:11], 0 offen sc1
    s_mov_b64 exec, -1

    s_lshl_b32 s21, s2, 3
    s_add_u32 s21, s21, s20
    s_lshl_b32 s21, s21, 14
    v_lshl_add_u32 v19, v1, 4, s21
    v_add_u32 v20, 0x200000, v19
    buffer_load_dwordx4 v[64:67], v20, s[8:11], 0 offen offset:0
    buffer_load_dwordx4 v[68:71], v20, s[8:11], 0 offen offset:1024
    buffer_load_dwordx4 v[72:75], v20, s[8:11], 0 offen offset:2048
    buffer_load_dwordx4 v[76:79], v20, s[8:11], 0 offen offset:3072
    v_add_u32 v20, 0x1000, v20
    buffer_load_dwordx4 v[80:83], v20, s[8:11], 0 offen offset:0
    buffer_load_dwordx4 v[84:87], v20, s[8:11], 0 offen offset:1024
    buffer_load_dwordx4 v[88:91], v20, s[8:11], 0 offen offset:2048
    buffer_load_dwordx4 v[92:95], v20, s[8:11], 0 offen offset:3072
    v_add_u32 v20, 0x1000, v20
    buffer_load_dwordx4 v[96:99], v20, s[8:11], 0 offen offset:0
    buffer_load_dwordx4 v[100:103], v20, s[8:11], 0 offen offset:1024
    buffer_load_dwordx4 v[104:107], v20, s[8:11], 0 offen offset:2048
    buffer_load_dwordx4 v[108:111], v20, s[8:11], 0 offen offset:3072
    v_add_u32 v20, 0x1000, v20
    buffer_load_dwordx4 v[112:115], v20, s[8:11], 0 offen offset:0
    buffer_load_dwordx4 v[116:119], v20, s[8:11], 0 offen offset:1024
    buffer_load_dwordx4 v[120:123], v20, s[8:11], 0 offen offset:2048
    buffer_load_dwordx4 v[124:127], v20, s[8:11], 0 offen offset:3072
    v_add_u32 v20, 0x600000, v19
    buffer_load_dwordx4 v[128:131], v20, s[8:11], 0 offen offset:0
    buffer_load_dwordx4 v[132:135], v20, s[8:11], 0 offen offset:1024
    buffer_load_dwordx4 v[136:139], v20, s[8:11], 0 offen offset:2048
    buffer_load_dwordx4 v[140:143], v20, s[8:11], 0 offen offset:3072
    v_add_u32 v20, 0x1000, v20
    buffer_load_dwordx4 v[144:147], v20, s[8:11], 0 offen offset:0
    buffer_load_dwordx4 v[148:151], v20, s[8:11], 0 offen offset:1024
    buffer_load_dwordx4 v[152:155], v20, s[8:11], 0 offen offset:2048
    buffer_load_dwordx4 v[156:159], v20, s[8:11], 0 offen offset:3072
    v_add_u32 v20, 0x1000, v20
    buffer_load_dwordx4 v[160:163], v20, s[8:11], 0 offen offset:0
    buffer_load_dwordx4 v[164:167], v20, s[8:11], 0 offen offset:1024
    buffer_load_dwordx4 v[168:171], v20, s[8:11], 0 offen offset:2048
    buffer_load_dwordx4 v[172:175], v20, s[8:11], 0 offen offset:3072
    v_add_u32 v20, 0x1000, v20
    buffer_load_dwordx4 v[176:179], v20, s[8:11], 0 offen offset:0
    buffer_load_dwordx4 v[180:183], v20, s[8:11], 0 offen offset:1024
    buffer_load_dwordx4 v[184:187], v20, s[8:11], 0 offen offset:2048
    buffer_load_dwordx4 v[188:191], v20, s[8:11], 0 offen offset:3072
    v_add_u32 v20, 0xa00000, v19
    buffer_load_dwordx4 v[192:195], v20, s[8:11], 0 offen offset:0
    buffer_load_dwordx4 v[196:199], v20, s[8:11], 0 offen offset:1024
    buffer_load_dwordx4 v[200:203], v20, s[8:11], 0 offen offset:2048
    buffer_load_dwordx4 v[204:207], v20, s[8:11], 0 offen offset:3072
    v_add_u32 v20, 0x1000, v20
    buffer_load_dwordx4 v[208:211], v20, s[8:11], 0 offen offset:0
    buffer_load_dwordx4 v[212:215], v20, s[8:11], 0 offen offset:1024
    buffer_load_dwordx4 v[216:219], v20, s[8:11], 0 offen offset:2048
    buffer_load_dwordx4 v[220:223], v20, s[8:11], 0 offen offset:3072
    v_add_u32 v20, 0x1000, v20
    buffer_load_dwordx4 v[224:227], v20, s[8:11], 0 offen offset:0
    buffer_load_dwordx4 v[228:231], v20, s[8:11], 0 offen offset:1024
    buffer_load_dwordx4 v[232:235], v20, s[8:11], 0 offen offset:2048
    buffer_load_dwordx4 v[236:239], v20, s[8:11], 0 offen offset:3072
    v_add_u32 v20, 0x1000, v20
    buffer_load_dwordx4 v[240:243], v20, s[8:11], 0 offen offset:0
    buffer_load_dwordx4 v[244:247], v20, s[8:11], 0 offen offset:1024
    buffer_load_dwordx4 v[248:251], v20, s[8:11], 0 offen offset:2048
    buffer_load_dwordx4 v[252:255], v20, s[8:11], 0 offen offset:3072
    s_lshl_b32 s21, s20, 19
    s_lshl_b32 s22, s2, 12
    s_add_u32 s21, s21, s22
    s_add_u32 s21, s21, 0xe00000
    v_lshl_add_u32 v20, v1, 4, s21
    s_lshl_b32 s22, s20, 14
    s_add_u32 s22, s22, 32768
    v_lshl_add_u32 v21, v1, 4, s22
    buffer_load_dwordx4 v[24:27], v20, s[8:11], 0 offen offset:0
    buffer_load_dwordx4 v[28:31], v20, s[8:11], 0 offen offset:1024
    buffer_load_dwordx4 v[32:35], v20, s[8:11], 0 offen offset:2048
    buffer_load_dwordx4 v[36:39], v20, s[8:11], 0 offen offset:3072
    s_waitcnt vmcnt(0)
    ds_write_b128 v21, v[24:27] offset:0
    ds_write_b128 v21, v[28:31] offset:1024
    ds_write_b128 v21, v[32:35] offset:2048
    ds_write_b128 v21, v[36:39] offset:3072
    v_add_u32 v20, 0x20000, v20
    s_waitcnt lgkmcnt(0)
    buffer_load_dwordx4 v[24:27], v20, s[8:11], 0 offen offset:0
    buffer_load_dwordx4 v[28:31], v20, s[8:11], 0 offen offset:1024
    buffer_load_dwordx4 v[32:35], v20, s[8:11], 0 offen offset:2048
    buffer_load_dwordx4 v[36:39], v20, s[8:11], 0 offen offset:3072
    s_waitcnt vmcnt(0)
    ds_write_b128 v21, v[24:27] offset:4096
    ds_write_b128 v21, v[28:31] offset:5120
    ds_write_b128 v21, v[32:35] offset:6144
    ds_write_b128 v21, v[36:39] offset:7168
    v_add_u32 v20, 0x20000, v20
    s_waitcnt lgkmcnt(0)
    buffer_load_dwordx4 v[24:27], v20, s[8:11], 0 offen offset:0
    buffer_load_dwordx4 v[28:31], v20, s[8:11], 0 offen offset:1024
    buffer_load_dwordx4 v[32:35], v20, s[8:11], 0 offen offset:2048
    buffer_load_dwordx4 v[36:39], v20, s[8:11], 0 offen offset:3072
    s_waitcnt vmcnt(0)
    ds_write_b128 v21, v[24:27] offset:8192
    ds_write_b128 v21, v[28:31] offset:9216
    ds_write_b128 v21, v[32:35] offset:10240
    ds_write_b128 v21, v[36:39] offset:11264
    v_add_u32 v20, 0x20000, v20
    s_waitcnt lgkmcnt(0)
    buffer_load_dwordx4 v[24:27], v20, s[8:11], 0 offen offset:0
    buffer_load_dwordx4 v[28:31], v20, s[8:11], 0 offen offset:1024
    buffer_load_dwordx4 v[32:35], v20, s[8:11], 0 offen offset:2048
    buffer_load_dwordx4 v[36:39], v20, s[8:11], 0 offen offset:3072
    s_waitcnt vmcnt(0)
    ds_write_b128 v21, v[24:27] offset:12288
    ds_write_b128 v21, v[28:31] offset:13312
    ds_write_b128 v21, v[32:35] offset:14336
    ds_write_b128 v21, v[36:39] offset:15360
    s_waitcnt lgkmcnt(0)
    v_lshlrev_b32 v5, 3, v3
    v_add_lshl_u32 v5, v5, v18, 4
    v_add_u32 v4, 0, v5
    s_and_b32 s21, s20, 1
    s_lshl_b32 s21, s21, 1
    v_lshrrev_b32 v6, 1, v3
    v_add_u32 v6, s21, v6
    v_lshlrev_b32 v6, 7, v6
    v_lshl_add_u32 v6, v18, 4, v6
    v_and_b32 v19, 1, v3
    v_lshl_add_u32 v6, v19, 3, v6
    s_lshr_b32 s21, s20, 1
    s_lshl_b32 s21, s21, 9
    v_add_u32 v6, s21, v6
    s_lshl_b32 s21, s20, 14
    s_add_u32 s21, s21, 32768
    v_lshl_add_u32 v7, v1, 4, s21
    s_and_b32 s23, s20, 3
    s_lshl_b32 s21, s23, 11
    v_lshl_add_u32 v9, v1, 4, s21
    v_add_u32 v8, 0x7000000, v9
    v_add_u32 v9, 0, v9
    s_lshl_b32 s21, s20, 16
    s_lshl_b32 s22, s2, 9
    s_add_u32 s21, s21, s22
    s_add_u32 s21, s21, 0x8000000
    v_add_u32 v10, s21, v5
    s_lshl_b32 s21, s2, 14
    s_lshl_b32 s22, s23, 7
    s_add_u32 s21, s21, s22
    s_add_u32 s21, s21, 0x8000000
    v_lshrrev_b32 v11, 3, v1
    v_lshlrev_b32 v11, 9, v11
    v_lshl_add_u32 v11, v18, 4, v11
    v_add_u32 v11, s21, v11
    v_and_b32 v12, 31, v1
    v_lshl_add_u32 v12, v12, 9, s21
    s_lshl_b32 s21, s2, 8
    s_lshl_b32 s22, s20, 5
    s_add_u32 s21, s21, s22
    v_lshlrev_b32 v13, 13, v18
    v_lshl_add_u32 v13, v3, 3, v13
    v_add_u32 v13, s21, v13
    v_add_u32 v13, 0x4800000, v13
    s_lshl_b32 s22, s21, 3
    v_lshl_add_u32 v14, v2, 4, s22
    v_and_b32 v19, 1, v3
    v_lshl_add_u32 v14, v19, 3, v14
    v_add_u32 v14, 0x4c00000, v14
    s_lshr_b32 s21, s20, 1
    s_lshl_b32 s21, s21, 4
    v_add_u32 v15, s21, v2
    v_lshlrev_b32 v15, 14, v15
    s_lshl_b32 s21, s2, 8
    s_and_b32 s22, s20, 1
    s_lshl_b32 s22, s22, 7
    s_add_u32 s21, s21, s22
    s_add_u32 s21, s21, 0x1802000
    v_lshl_add_u32 v15, v3, 4, v15
    v_add_u32 v15, s21, v15
    s_lshl_b32 s21, s2, 7
    s_lshl_b32 s22, s20, 4
    s_add_u32 s21, s21, s22
    v_lshrrev_b32 v16, 2, v1
    v_add_u32 v16, s21, v16
    v_lshlrev_b32 v16, 12, v16
    v_and_b32 v19, 3, v1
    v_lshl_add_u32 v16, v19, 4, v16
    v_add_u32 v16, 0x3800000, v16
    s_lshr_b32 s21, s23, 1
    s_lshl_b32 s21, s21, 7
    s_and_b32 s22, s23, 1
    s_lshl_b32 s22, s22, 3
    s_add_u32 s21, s21, s22
    s_lshl_b32 s22, s2, 8
    s_add_u32 s21, s21, s22
    s_add_u32 s21, s21, 0x7002000
    v_lshl_add_u32 v17, v18, 4, s21
    v_cmp_gt_u32 s[40:41], 2, v3
    s_mov_b32 s30, 0
    s_mov_b32 s31, 0
    s_mov_b32 s32, 0
    s_mov_b32 s33, 0
    s_mov_b32 s34, 0
    s_mov_b32 s35, 0

    v_and_b32 v20, 31, v1
    v_lshlrev_b32 v20, 2, v20
    v_add_u32 v20, 0x7106000, v20
    s_mov_b32 s36, 0

.xc15:
    buffer_load_dword v21, v20, s[8:11], 0 offen sc1
    s_add_u32 s36, s36, 1
    s_waitcnt vmcnt(0)
    v_cmp_eq_u32 vcc, 0, v21
    s_cmp_lt_u32 s36, 131072
    s_cselect_b64 s[44:45], vcc, 0
    s_cmp_lg_u64 s[44:45], 0
    s_cbranch_scc1 .xc15
    v_readfirstlane_b32 s21, v21
    s_nop 3
    v_cmp_ne_u32 vcc, s21, v21
    s_cmp_lg_u64 vcc, 0

    s_cbranch_scc1 .slow16
    s_cmp_ge_u32 s20, 4
    s_cbranch_scc1 .ip17
    s_lshl_b32 s21, s2, 2
    s_add_u32 s21, s21, 0x7100000
    v_mov_b32 v20, s21
    s_mov_b32 s37, 0
.wf18:
    buffer_load_dword v21, v20, s[8:11], 0 offen sc1
    s_waitcnt vmcnt(0)
    v_readfirstlane_b32 s38, v21
    s_add_u32 s37, s37, 1
    s_cmp_lg_u32 s38, 0
    s_cbranch_scc1 .wfd19
    s_sleep 2
    s_cmp_lt_u32 s37, 1048576
    s_cbranch_scc1 .wf18
.wfd19:
    s_lshl_b32 s21, s20, 11
    s_add_u32 s21, s21, 8192
    s_mov_b32 m0, s21
    s_nop 0
    buffer_load_dwordx4 v15, s[8:11], s34 offen sc1 lds
    s_add_u32 s21, s21, 1024
    s_mov_b32 m0, s21
    v_add_u32 v0, 64, v15
    buffer_load_dwordx4 v0, s[8:11], s34 offen sc1 lds
    s_lshl_b32 s21, s20, 10
    s_add_u32 s21, s21, 24576
    s_mov_b32 m0, s21
    s_nop 0
    buffer_load_dwordx4 v16, s[8:11], s35 offen sc1 lds
    s_add_u32 s21, s21, 4096
    s_mov_b32 m0, s21
    v_add_u32 v0, 0x40000, v16
    buffer_load_dwordx4 v0, s[8:11], s35 offen sc1 lds
.ip17:
.step20:
    s_cmp_ge_u32 s20, 4
    s_cbranch_scc1 .g121
    s_branch .b122
.g121:
    s_mov_b32 s36, 0
    buffer_load_dwordx4 v[20:23], v8, s[8:11], s31 offen sc1
    buffer_load_dwordx4 v[24:27], v8, s[8:11], s31 offen offset:1024 sc1
.p223:
    buffer_load_dwordx4 v[28:31], v8, s[8:11], s31 offen sc1
    buffer_load_dwordx4 v[32:35], v8, s[8:11], s31 offen offset:1024 sc1
    s_waitcnt vmcnt(2)
    v_max_u32 v36, v20, v21
    v_max3_u32 v36, v36, v22, v23
    v_max3_u32 v36, v36, v24, v25
    v_max3_u32 v36, v36, v26, v27
    v_cmp_ne_u32 vcc, -1, v36
    s_cmp_eq_u64 vcc, exec
    s_cbranch_scc1 .p2a24
    buffer_load_dwordx4 v[20:23], v8, s[8:11], s31 offen sc1
    buffer_load_dwordx4 v[24:27], v8, s[8:11], s31 offen offset:1024 sc1
    s_waitcnt vmcnt(2)
    v_max_u32 v36, v28, v29
    v_max3_u32 v36, v36, v30, v31
    v_max3_u32 v36, v36, v32, v33
    v_max3_u32 v36, v36, v34, v35
    v_cmp_ne_u32 vcc, -1, v36
    s_cmp_eq_u64 vcc, exec
    s_cbranch_scc1 .p2b25
    s_add_u32 s36, s36, 1
    s_cmp_lt_u32 s36, 131072
    s_cbranch_scc1 .p223
    s_branch .p2a24
.p2b25:
    ds_write_b128 v9, v[28:31]
    ds_write_b128 v9, v[32:35] offset:1024
    s_branch .p2j26
.p2a24:
    ds_write_b128 v9, v[20:23]
    ds_write_b128 v9, v[24:27] offset:1024
.p2j26:
    s_waitcnt vmcnt(0)
.b122:
    s_waitcnt lgkmcnt(0)
    s_barrier
    s_cmp_lt_u32 s20, 4
    s_cbranch_scc1 .wm227
    buffer_load_dword v62, v12, s[8:11], s32 offen sc1
    s_add_u32 s21, s31, 8192
    v_lshlrev_b32 v0, 4, v1
    v_sub_u32 v0, v8, v0
    v_lshl_add_u32 v0, v1, 5, v0
    buffer_load_dword v63, v0, s[8:11], s21 offen sc1
.wm227:
    v_mov_b32 v36, 0
    v_mov_b32 v37, 0
    v_mov_b32 v38, 0
    v_mov_b32 v39, 0
    v_mov_b32 v40, 0
    v_mov_b32 v41, 0
    v_mov_b32 v42, 0
    v_mov_b32 v43, 0
    ds_read_b128 v[20:23], v4
    ds_read_b128 v[24:27], v4 offset:512
    ds_read_b128 v[28:31], v4 offset:1024
    ds_read_b128 v[32:35], v4 offset:1536
    s_waitcnt lgkmcnt(3)
    v_mfma_f32_16x16x32_bf16 v[36:39], v[64:67], v[20:23], v[36:39]
    v_mfma_f32_16x16x32_bf16 v[40:43], v[128:131], v[20:23], v[40:43]
    ds_read_b128 v[20:23], v4 offset:2048
    s_waitcnt lgkmcnt(3)
    v_mfma_f32_16x16x32_bf16 v[36:39], v[68:71], v[24:27], v[36:39]
    v_mfma_f32_16x16x32_bf16 v[40:43], v[132:135], v[24:27], v[40:43]
    ds_read_b128 v[24:27], v4 offset:2560
    s_waitcnt lgkmcnt(3)
    v_mfma_f32_16x16x32_bf16 v[36:39], v[72:75], v[28:31], v[36:39]
    v_mfma_f32_16x16x32_bf16 v[40:43], v[136:139], v[28:31], v[40:43]
    ds_read_b128 v[28:31], v4 offset:3072
    s_waitcnt lgkmcnt(3)
    v_mfma_f32_16x16x32_bf16 v[36:39], v[76:79], v[32:35], v[36:39]
    v_mfma_f32_16x16x32_bf16 v[40:43], v[140:143], v[32:35], v[40:43]
    ds_read_b128 v[32:35], v4 offset:3584
    s_waitcnt lgkmcnt(3)
    v_mfma_f32_16x16x32_bf16 v[36:39], v[80:83], v[20:23], v[36:39]
    v_mfma_f32_16x16x32_bf16 v[40:43], v[144:147], v[20:23], v[40:43]
    ds_read_b128 v[20:23], v4 offset:4096
    s_waitcnt lgkmcnt(3)
    v_mfma_f32_16x16x32_bf16 v[36:39], v[84:87], v[24:27], v[36:39]
    v_mfma_f32_16x16x32_bf16 v[40:43], v[148:151], v[24:27], v[40:43]
    ds_read_b128 v[24:27], v4 offset:4608
    s_waitcnt lgkmcnt(3)
    v_mfma_f32_16x16x32_bf16 v[36:39], v[88:91], v[28:31], v[36:39]
    v_mfma_f32_16x16x32_bf16 v[40:43], v[152:155], v[28:31], v[40:43]
    ds_read_b128 v[28:31], v4 offset:5120
    s_waitcnt lgkmcnt(3)
    v_mfma_f32_16x16x32_bf16 v[36:39], v[92:95], v[32:35], v[36:39]
    v_mfma_f32_16x16x32_bf16 v[40:43], v[156:159], v[32:35], v[40:43]
    ds_read_b128 v[32:35], v4 offset:5632
    s_waitcnt lgkmcnt(3)
    v_mfma_f32_16x16x32_bf16 v[36:39], v[96:99], v[20:23], v[36:39]
    v_mfma_f32_16x16x32_bf16 v[40:43], v[160:163], v[20:23], v[40:43]
    ds_read_b128 v[20:23], v4 offset:6144
    s_waitcnt lgkmcnt(3)
    v_mfma_f32_16x16x32_bf16 v[36:39], v[100:103], v[24:27], v[36:39]
    v_mfma_f32_16x16x32_bf16 v[40:43], v[164:167], v[24:27], v[40:43]
    ds_read_b128 v[24:27], v4 offset:6656
    s_waitcnt lgkmcnt(3)
    v_mfma_f32_16x16x32_bf16 v[36:39], v[104:107], v[28:31], v[36:39]
    v_mfma_f32_16x16x32_bf16 v[40:43], v[168:171], v[28:31], v[40:43]
    ds_read_b128 v[28:31], v4 offset:7168
    s_waitcnt lgkmcnt(3)
    v_mfma_f32_16x16x32_bf16 v[36:39], v[108:111], v[32:35], v[36:39]
    v_mfma_f32_16x16x32_bf16 v[40:43], v[172:175], v[32:35], v[40:43]
    ds_read_b128 v[32:35], v4 offset:7680
    s_waitcnt lgkmcnt(3)
    v_mfma_f32_16x16x32_bf16 v[36:39], v[112:115], v[20:23], v[36:39]
    v_mfma_f32_16x16x32_bf16 v[40:43], v[176:179], v[20:23], v[40:43]
    s_waitcnt lgkmcnt(2)
    v_mfma_f32_16x16x32_bf16 v[36:39], v[116:119], v[24:27], v[36:39]
    v_mfma_f32_16x16x32_bf16 v[40:43], v[180:183], v[24:27], v[40:43]
    s_waitcnt lgkmcnt(1)
    v_mfma_f32_16x16x32_bf16 v[36:39], v[120:123], v[28:31], v[36:39]
    v_mfma_f32_16x16x32_bf16 v[40:43], v[184:187], v[28:31], v[40:43]
    s_waitcnt lgkmcnt(0)
    v_mfma_f32_16x16x32_bf16 v[36:39], v[124:127], v[32:35], v[36:39]
    v_mfma_f32_16x16x32_bf16 v[40:43], v[188:191], v[32:35], v[40:43]
    s_nop 7
    s_nop 1
    v_cvt_pk_bf16_f32 v20, v36, v37
    v_cvt_pk_bf16_f32 v21, v38, v39
    v_cvt_pk_bf16_f32 v22, v40, v41
    v_cvt_pk_bf16_f32 v23, v42, v43

    ds_write_b64 v6, v[20:21] offset:16384
    ds_write_b64 v6, v[22:23] offset:18432
    buffer_store_dwordx2 v[22:23], v13, s[8:11], s33 offen sc1
    s_cmp_eq_u32 s30, 63
    s_cbranch_scc1 .last28
    s_cmp_ge_u32 s20, 4
    s_cbranch_scc1 .nw229
    s_waitcnt vmcnt(1)
.nw229:
    s_waitcnt lgkmcnt(0)
    s_barrier
    s_cmp_lg_u32 s20, 5
    s_cbranch_scc1 .nf30
    s_cmp_eq_u32 s30, 0
    s_cbranch_scc1 .nf30
    s_lshl_b32 s21, s30, 7
    s_lshl_b32 s22, s2, 2
    s_add_u32 s21, s21, s22
    s_add_u32 s21, s21, 0x7101f80
    v_mov_b32 v36, s21
    v_mov_b32 v37, 1
    s_mov_b64 s[54:55], exec
    s_mov_b64 exec, 1
    buffer_store_dword v37, v36, s[8:11], 0 offen sc1
    s_mov_b64 exec, s[54:55]
.nf30:
    s_cmp_lt_u32 s20, 4
    s_cbranch_scc1 .p332
    v_mov_b32 v44, 0
    v_mov_b32 v45, 0
    v_mov_b32 v46, 0
    v_mov_b32 v47, 0
    ds_read_b128 v[20:23], v4
    ds_read_b128 v[24:27], v4 offset:512
    ds_read_b128 v[28:31], v4 offset:1024
    ds_read_b128 v[32:35], v4 offset:1536
    s_waitcnt lgkmcnt(3)
    v_mfma_f32_16x16x32_bf16 v[44:47], v[20:23], v[192:195], v[44:47]
    ds_read_b128 v[20:23], v4 offset:2048
    s_waitcnt lgkmcnt(3)
    v_mfma_f32_16x16x32_bf16 v[44:47], v[24:27], v[196:199], v[44:47]
    ds_read_b128 v[24:27], v4 offset:2560
    s_waitcnt lgkmcnt(3)
    v_mfma_f32_16x16x32_bf16 v[44:47], v[28:31], v[200:203], v[44:47]
    ds_read_b128 v[28:31], v4 offset:3072
    s_waitcnt lgkmcnt(3)
    v_mfma_f32_16x16x32_bf16 v[44:47], v[32:35], v[204:207], v[44:47]
    ds_read_b128 v[32:35], v4 offset:3584
    s_waitcnt lgkmcnt(3)
    v_mfma_f32_16x16x32_bf16 v[44:47], v[20:23], v[208:211], v[44:47]
    ds_read_b128 v[20:23], v4 offset:4096
    s_waitcnt lgkmcnt(3)
    v_mfma_f32_16x16x32_bf16 v[44:47], v[24:27], v[212:215], v[44:47]
    ds_read_b128 v[24:27], v4 offset:4608
    s_waitcnt lgkmcnt(3)
    v_mfma_f32_16x16x32_bf16 v[44:47], v[28:31], v[216:219], v[44:47]
    ds_read_b128 v[28:31], v4 offset:5120
    s_waitcnt lgkmcnt(3)
    v_mfma_f32_16x16x32_bf16 v[44:47], v[32:35], v[220:223], v[44:47]
    ds_read_b128 v[32:35], v4 offset:5632
    s_waitcnt lgkmcnt(3)
    v_mfma_f32_16x16x32_bf16 v[44:47], v[20:23], v[224:227], v[44:47]
    ds_read_b128 v[20:23], v4 offset:6144
    s_waitcnt lgkmcnt(3)
    v_mfma_f32_16x16x32_bf16 v[44:47], v[24:27], v[228:231], v[44:47]
    ds_read_b128 v[24:27], v4 offset:6656
    s_waitcnt lgkmcnt(3)
    v_mfma_f32_16x16x32_bf16 v[44:47], v[28:31], v[232:235], v[44:47]
    ds_read_b128 v[28:31], v4 offset:7168
    s_waitcnt lgkmcnt(3)
    v_mfma_f32_16x16x32_bf16 v[44:47], v[32:35], v[236:239], v[44:47]
    ds_read_b128 v[32:35], v4 offset:7680
    s_waitcnt lgkmcnt(3)
    v_mfma_f32_16x16x32_bf16 v[44:47], v[20:23], v[240:243], v[44:47]
    s_waitcnt lgkmcnt(2)
    v_mfma_f32_16x16x32_bf16 v[44:47], v[24:27], v[244:247], v[44:47]
    s_waitcnt lgkmcnt(1)
    v_mfma_f32_16x16x32_bf16 v[44:47], v[28:31], v[248:251], v[44:47]
    s_waitcnt lgkmcnt(0)
    v_mfma_f32_16x16x32_bf16 v[44:47], v[32:35], v[252:255], v[44:47]
    s_nop 7
    s_nop 1
    v_cvt_pk_bf16_f32 v18, v44, v45
    v_cvt_pk_bf16_f32 v19, v46, v47
    s_lshl_b32 s21, s20, 9
    v_lshl_add_u32 v0, v1, 3, s21
    ds_write_b64 v0, v[18:19] offset:20480
    buffer_store_dwordx2 v[18:19], v14, s[8:11], s33 offen sc1
    s_waitcnt lgkmcnt(0)
    s_barrier
    s_branch .sk331
.p332:
    ds_read_b128 v[20:23], v5 offset:16384
    ds_read_b128 v[24:27], v5 offset:16896
    ds_read_b128 v[28:31], v5 offset:17408
    ds_read_b128 v[32:35], v5 offset:17920
    v_lshlrev_b32 v0, 4, v1
    ds_read_b128 v[48:51], v5 offset:18432
    ds_read_b128 v[52:55], v5 offset:18944
    ds_read_b128 v[56:59], v5 offset:19456
    v_mov_b32 v36, 0
    v_mov_b32 v37, 0
    v_mov_b32 v38, 0
    v_mov_b32 v39, 0
    v_mov_b32 v40, 0
    v_mov_b32 v41, 0
    v_mov_b32 v42, 0
    v_mov_b32 v43, 0
    v_mov_b32 v44, 0
    v_mov_b32 v45, 0
    v_mov_b32 v46, 0
    v_mov_b32 v47, 0
    ds_read_b128 v[60:63], v5 offset:19968
    s_waitcnt lgkmcnt(3)
    v_mfma_f32_16x16x32_bf16 v[36:39], v[48:51], v[20:23], v[36:39]
    ds_read_b128 v[48:51], v0 offset:8192
    s_waitcnt lgkmcnt(3)
    v_mfma_f32_16x16x32_bf16 v[36:39], v[52:55], v[24:27], v[36:39]
    ds_read_b128 v[52:55], v0 offset:9216
    s_waitcnt lgkmcnt(3)
    v_mfma_f32_16x16x32_bf16 v[36:39], v[56:59], v[28:31], v[36:39]
    ds_read_b128 v[56:59], v0 offset:10240
    s_waitcnt lgkmcnt(3)
    v_mfma_f32_16x16x32_bf16 v[36:39], v[60:63], v[32:35], v[36:39]
    ds_read_b128 v[60:63], v0 offset:11264
    s_waitcnt lgkmcnt(3)
    v_mfma_f32_16x16x32_bf16 v[40:43], v[48:51], v[20:23], v[40:43]
    ds_read_b128 v[48:51], v0 offset:12288
    s_waitcnt lgkmcnt(3)
    v_mfma_f32_16x16x32_bf16 v[40:43], v[52:55], v[24:27], v[40:43]
    ds_read_b128 v[52:55], v0 offset:13312
    s_waitcnt lgkmcnt(3)
    v_mfma_f32_16x16x32_bf16 v[40:43], v[56:59], v[28:31], v[40:43]
    ds_read_b128 v[56:59], v0 offset:14336
    s_waitcnt lgkmcnt(3)
    v_mfma_f32_16x16x32_bf16 v[40:43], v[60:63], v[32:35], v[40:43]
    ds_read_b128 v[60:63], v0 offset:15360
    s_waitcnt lgkmcnt(3)
    v_mfma_f32_16x16x32_bf16 v[44:47], v[48:51], v[20:23], v[44:47]
    s_waitcnt lgkmcnt(2)
    v_mfma_f32_16x16x32_bf16 v[44:47], v[52:55], v[24:27], v[44:47]
    s_waitcnt lgkmcnt(1)
    v_mfma_f32_16x16x32_bf16 v[44:47], v[56:59], v[28:31], v[44:47]
    s_waitcnt lgkmcnt(0)
    v_mfma_f32_16x16x32_bf16 v[44:47], v[60:63], v[32:35], v[44:47]
    ds_read_b128 v[48:51], v4 offset:0
    ds_read_b128 v[52:55], v4 offset:512
    ds_read_b128 v[56:59], v4 offset:1024
    ds_read_b128 v[60:63], v4 offset:1536
    v_mov_b32 v24, 0
    v_mov_b32 v25, 0
    v_mov_b32 v26, 0
    v_mov_b32 v27, 0
    s_nop 4
    v_cvt_pk_bf16_f32 v20, v36, v37
    v_lshlrev_b32 v36, 16, v20
    v_and_b32 v37, 0xffff0000, v20
    v_mul_f32 v36, 0x3db504f3, v36
    v_mul_f32 v37, 0x3db504f3, v37
    v_cvt_pk_bf16_f32 v20, v36, v37
    v_lshlrev_b32 v36, 16, v20
    v_and_b32 v37, 0xffff0000, v20
    s_waitcnt lgkmcnt(3)
    v_mfma_f32_16x16x32_bf16 v[24:27], v[48:51], v[192:195], v[24:27]
    ds_read_b128 v[48:51], v4 offset:2048
    v_cvt_pk_bf16_f32 v20, v38, v39
    v_lshlrev_b32 v38, 16, v20
    v_and_b32 v39, 0xffff0000, v20
    v_mul_f32 v38, 0x3db504f3, v38
    v_mul_f32 v39, 0x3db504f3, v39
    v_cvt_pk_bf16_f32 v20, v38, v39
    v_lshlrev_b32 v38, 16, v20
    v_and_b32 v39, 0xffff0000, v20
    s_waitcnt lgkmcnt(3)
    v_mfma_f32_16x16x32_bf16 v[24:27], v[52:55], v[196:199], v[24:27]
    ds_read_b128 v[52:55], v4 offset:2560
    v_cvt_pk_bf16_f32 v20, v40, v41
    v_lshlrev_b32 v40, 16, v20
    v_and_b32 v41, 0xffff0000, v20
    v_mul_f32 v40, 0x3db504f3, v40
    v_mul_f32 v41, 0x3db504f3, v41
    v_cvt_pk_bf16_f32 v20, v40, v41
    v_lshlrev_b32 v40, 16, v20
    v_and_b32 v41, 0xffff0000, v20
    s_waitcnt lgkmcnt(3)
    v_mfma_f32_16x16x32_bf16 v[24:27], v[56:59], v[200:203], v[24:27]
    ds_read_b128 v[56:59], v4 offset:3072
    v_cvt_pk_bf16_f32 v20, v42, v43
    v_lshlrev_b32 v42, 16, v20
    v_and_b32 v43, 0xffff0000, v20
    v_mul_f32 v42, 0x3db504f3, v42
    v_mul_f32 v43, 0x3db504f3, v43
    v_cvt_pk_bf16_f32 v20, v42, v43
    v_lshlrev_b32 v42, 16, v20
    v_and_b32 v43, 0xffff0000, v20
    s_waitcnt lgkmcnt(3)
    v_mfma_f32_16x16x32_bf16 v[24:27], v[60:63], v[204:207], v[24:27]
    ds_read_b128 v[60:63], v4 offset:3584
    v_cvt_pk_bf16_f32 v20, v44, v45
    v_lshlrev_b32 v44, 16, v20
    v_and_b32 v45, 0xffff0000, v20
    v_mul_f32 v44, 0x3db504f3, v44
    v_mul_f32 v45, 0x3db504f3, v45
    v_cvt_pk_bf16_f32 v20, v44, v45
    v_lshlrev_b32 v44, 16, v20
    v_and_b32 v45, 0xffff0000, v20
    s_waitcnt lgkmcnt(3)
    v_mfma_f32_16x16x32_bf16 v[24:27], v[48:51], v[208:211], v[24:27]
    ds_read_b128 v[48:51], v4 offset:4096
    v_cvt_pk_bf16_f32 v20, v46, v47
    v_lshlrev_b32 v46, 16, v20
    v_and_b32 v47, 0xffff0000, v20
    v_mul_f32 v46, 0x3db504f3, v46
    v_mul_f32 v47, 0x3db504f3, v47
    v_cvt_pk_bf16_f32 v20, v46, v47
    v_lshlrev_b32 v46, 16, v20
    v_and_b32 v47, 0xffff0000, v20
    s_waitcnt lgkmcnt(3)
    v_mfma_f32_16x16x32_bf16 v[24:27], v[52:55], v[212:215], v[24:27]
    ds_read_b128 v[52:55], v4 offset:4608
    v_mov_b32 v20, 0xff800000
    v_cndmask_b32 v36, v20, v36, s[40:41]
    v_cndmask_b32 v37, v20, v37, s[40:41]
    v_cndmask_b32 v38, v20, v38, s[40:41]
    v_cndmask_b32 v39, v20, v39, s[40:41]
    v_max_f32 v21, v36, v37
    v_max_f32 v21, v21, v38
    v_max_f32 v21, v21, v39
    s_waitcnt lgkmcnt(3)
    v_mfma_f32_16x16x32_bf16 v[24:27], v[56:59], v[216:219], v[24:27]
    ds_read_b128 v[56:59], v4 offset:5120
    v_max_f32 v21, v21, v40
    v_max_f32 v21, v21, v41
    v_max_f32 v21, v21, v42
    v_max_f32 v21, v21, v43
    v_max_f32 v21, v21, v44
    v_max_f32 v21, v21, v45
    v_max_f32 v21, v21, v46
    v_max_f32 v21, v21, v47
    s_waitcnt lgkmcnt(3)
    v_mfma_f32_16x16x32_bf16 v[24:27], v[60:63], v[220:223], v[24:27]
    ds_read_b128 v[60:63], v4 offset:5632
    v_mov_b32 v23, v21
    s_nop 1
    v_permlane16_swap_b32 v21, v23
    s_nop 1
    v_max_f32 v21, v21, v23
    v_mov_b32 v23, v21
    s_nop 1
    v_permlane32_swap_b32 v21, v23
    s_waitcnt lgkmcnt(3)
    v_mfma_f32_16x16x32_bf16 v[24:27], v[48:51], v[224:227], v[24:27]
    ds_read_b128 v[48:51], v4 offset:6144
    s_nop 1
    v_max_f32 v21, v21, v23
    v_sub_f32 v36, v36, v21
    v_mul_f32 v36, 0x3fb8aa3b, v36
    v_exp_f32 v36, v36
    v_sub_f32 v37, v37, v21
    v_mul_f32 v37, 0x3fb8aa3b, v37
    v_exp_f32 v37, v37
    s_waitcnt lgkmcnt(3)
    v_mfma_f32_16x16x32_bf16 v[24:27], v[52:55], v[228:231], v[24:27]
    ds_read_b128 v[52:55], v4 offset:6656
    v_sub_f32 v38, v38, v21
    v_mul_f32 v38, 0x3fb8aa3b, v38
    v_exp_f32 v38, v38
    v_sub_f32 v39, v39, v21
    v_mul_f32 v39, 0x3fb8aa3b, v39
    v_exp_f32 v39, v39
    v_sub_f32 v40, v40, v21
    v_mul_f32 v40, 0x3fb8aa3b, v40
    s_waitcnt lgkmcnt(3)
    v_mfma_f32_16x16x32_bf16 v[24:27], v[56:59], v[232:235], v[24:27]
    ds_read_b128 v[56:59], v4 offset:7168
    v_exp_f32 v40, v40
    v_sub_f32 v41, v41, v21
    v_mul_f32 v41, 0x3fb8aa3b, v41
    v_exp_f32 v41, v41
    v_sub_f32 v42, v42, v21
    v_mul_f32 v42, 0x3fb8aa3b, v42
    v_exp_f32 v42, v42
    v_sub_f32 v43, v43, v21
    s_waitcnt lgkmcnt(3)
    v_mfma_f32_16x16x32_bf16 v[24:27], v[60:63], v[236:239], v[24:27]
    ds_read_b128 v[60:63], v4 offset:7680
    v_mul_f32 v43, 0x3fb8aa3b, v43
    v_exp_f32 v43, v43
    v_sub_f32 v44, v44, v21
    v_mul_f32 v44, 0x3fb8aa3b, v44
    v_exp_f32 v44, v44
    v_sub_f32 v45, v45, v21
    v_mul_f32 v45, 0x3fb8aa3b, v45
    v_exp_f32 v45, v45
    s_waitcnt lgkmcnt(3)
    v_mfma_f32_16x16x32_bf16 v[24:27], v[48:51], v[240:243], v[24:27]
    v_sub_f32 v46, v46, v21
    v_mul_f32 v46, 0x3fb8aa3b, v46
    v_exp_f32 v46, v46
    v_sub_f32 v47, v47, v21
    v_mul_f32 v47, 0x3fb8aa3b, v47
    v_exp_f32 v47, v47
    s_nop 0
    v_add_f32 v22, v36, v37
    s_waitcnt lgkmcnt(2)
    v_mfma_f32_16x16x32_bf16 v[24:27], v[52:55], v[244:247], v[24:27]
    v_add_f32 v22, v22, v38
    v_add_f32 v22, v22, v39
    v_add_f32 v22, v22, v40
    v_add_f32 v22, v22, v41
    v_add_f32 v22, v22, v42
    v_add_f32 v22, v22, v43
    v_add_f32 v22, v22, v44
    v_add_f32 v22, v22, v45
    s_waitcnt lgkmcnt(1)
    v_mfma_f32_16x16x32_bf16 v[24:27], v[56:59], v[248:251], v[24:27]
    v_add_f32 v22, v22, v46
    v_add_f32 v22, v22, v47
    v_mov_b32 v23, v22
    s_nop 1
    v_permlane16_swap_b32 v22, v23
    s_nop 1
    v_add_f32 v22, v22, v23
    v_mov_b32 v23, v22
    s_waitcnt lgkmcnt(0)
    v_mfma_f32_16x16x32_bf16 v[24:27], v[60:63], v[252:255], v[24:27]
    s_nop 1
    v_permlane32_swap_b32 v22, v23
    s_nop 1
    v_add_f32 v22, v22, v23
    v_rcp_f32 v22, v22
    s_nop 0
    v_mul_f32 v36, v36, v22
    v_mul_f32 v37, v37, v22
    v_mul_f32 v38, v38, v22
    v_mul_f32 v39, v39, v22
    v_mul_f32 v40, v40, v22
    v_mul_f32 v41, v41, v22
    v_mul_f32 v42, v42, v22
    v_mul_f32 v43, v43, v22
    v_mul_f32 v44, v44, v22
    v_mul_f32 v45, v45, v22
    v_mul_f32 v46, v46, v22
    v_mul_f32 v47, v47, v22
    v_cvt_pk_bf16_f32 v28, v36, v37
    v_cvt_pk_bf16_f32 v29, v38, v39
    v_cvt_pk_bf16_f32 v30, v40, v41
    v_cvt_pk_bf16_f32 v31, v42, v43
    v_cvt_pk_bf16_f32 v32, v44, v45
    v_cvt_pk_bf16_f32 v33, v46, v47
    s_nop 3
    v_cvt_pk_bf16_f32 v18, v24, v25
    v_cvt_pk_bf16_f32 v19, v26, v27
    buffer_store_dwordx2 v[18:19], v14, s[8:11], s33 offen sc1
    s_barrier
    s_lshl_b32 s21, s20, 9
    v_lshl_add_u32 v0, v1, 3, s21
    ds_read_b64 v[48:49], v0 offset:22528
    s_lshl_b32 s21, s20, 10
    v_lshlrev_b32 v0, 6, v2
    v_lshl_add_u32 v0, v3, 3, v0
    v_add_u32 v0, s21, v0
    ds_read_b64 v[60:61], v0 offset:24576
    ds_read_b64 v[62:63], v0 offset:24608
    ds_read_b64 v[52:53], v0 offset:28672
    ds_read_b64 v[54:55], v0 offset:28704
    v_mov_b32 v36, 0
    v_mov_b32 v37, 0
    v_mov_b32 v38, 0
    v_mov_b32 v39, 0
    v_mov_b32 v40, 0
    v_mov_b32 v41, 0
    v_mov_b32 v42, 0
    v_mov_b32 v43, 0
    s_waitcnt lgkmcnt(0)
    v_mfma_f32_16x16x16_bf16 v[36:39], v[18:19], v[28:29], v[36:39]
    v_mfma_f32_16x16x16_bf16 v[40:43], v[48:49], v[28:29], v[40:43]
    s_nop 7
    v_mfma_f32_16x16x32_bf16 v[36:39], v[60:63], v[30:33], v[36:39]
    v_mfma_f32_16x16x32_bf16 v[40:43], v[52:55], v[30:33], v[40:43]
    s_nop 7
    s_nop 1
    v_cvt_pk_bf16_f32 v20, v36, v37
    v_cvt_pk_bf16_f32 v21, v38, v39
    v_cvt_pk_bf16_f32 v22, v40, v41
    v_cvt_pk_bf16_f32 v23, v42, v43
    ds_write_b64 v6, v[20:21] offset:20480
    ds_write_b64 v6, v[22:23] offset:21504
    s_waitcnt lgkmcnt(0)
.sk331:
    ds_read_b128 v[36:39], v7 offset:0
    ds_read_b128 v[40:43], v7 offset:1024
    ds_read_b128 v[44:47], v7 offset:2048
    ds_read_b128 v[48:51], v7 offset:3072
    s_waitcnt vmcnt(2)
    s_barrier
    ds_read_b128 v[20:23], v5 offset:20480
    ds_read_b128 v[24:27], v5 offset:20992
    ds_read_b128 v[28:31], v5 offset:21504
    ds_read_b128 v[32:35], v5 offset:22016
    v_mov_b32 v0, v10
    v_mov_b32 v56, 0
    v_mov_b32 v57, 0
    v_mov_b32 v58, 0
    v_mov_b32 v59, 0
    ds_read_b128 v[52:55], v7 offset:4096
    s_waitcnt lgkmcnt(0)
    v_mfma_f32_16x16x32_bf16 v[56:59], v[36:39], v[20:23], v[56:59]
    ds_read_b128 v[36:39], v7 offset:5120
    s_waitcnt lgkmcnt(4)
    v_mfma_f32_16x16x32_bf16 v[56:59], v[40:43], v[24:27], v[56:59]
    ds_read_b128 v[40:43], v7 offset:6144
    s_waitcnt lgkmcnt(4)
    v_mfma_f32_16x16x32_bf16 v[56:59], v[44:47], v[28:31], v[56:59]
    ds_read_b128 v[44:47], v7 offset:7168
    s_waitcnt lgkmcnt(4)
    v_mfma_f32_16x16x32_bf16 v[56:59], v[48:51], v[32:35], v[56:59]
    s_nop 7
    s_nop 1
    v_min_u32 v56, -2, v56
    v_min_u32 v57, -2, v57
    v_min_u32 v58, -2, v58
    v_min_u32 v59, -2, v59
    buffer_store_dwordx4 v[56:59], v0, s[8:11], s32 offen
    v_add_u32 v0, 0x4000, v0
    v_mov_b32 v60, 0
    v_mov_b32 v61, 0
    v_mov_b32 v62, 0
    v_mov_b32 v63, 0
    ds_read_b128 v[48:51], v7 offset:8192
    s_waitcnt lgkmcnt(4)
    v_mfma_f32_16x16x32_bf16 v[60:63], v[52:55], v[20:23], v[60:63]
    ds_read_b128 v[52:55], v7 offset:9216
    s_waitcnt lgkmcnt(4)
    v_mfma_f32_16x16x32_bf16 v[60:63], v[36:39], v[24:27], v[60:63]
    ds_read_b128 v[36:39], v7 offset:10240
    s_waitcnt lgkmcnt(4)
    v_mfma_f32_16x16x32_bf16 v[60:63], v[40:43], v[28:31], v[60:63]
    ds_read_b128 v[40:43], v7 offset:11264
    s_waitcnt lgkmcnt(4)
    v_mfma_f32_16x16x32_bf16 v[60:63], v[44:47], v[32:35], v[60:63]
    s_nop 7
    s_nop 1
    v_min_u32 v60, -2, v60
    v_min_u32 v61, -2, v61
    v_min_u32 v62, -2, v62
    v_min_u32 v63, -2, v63
    buffer_store_dwordx4 v[60:63], v0, s[8:11], s32 offen
    v_add_u32 v0, 0x4000, v0
    v_mov_b32 v56, 0
    v_mov_b32 v57, 0
    v_mov_b32 v58, 0
    v_mov_b32 v59, 0
    ds_read_b128 v[44:47], v7 offset:12288
    s_waitcnt lgkmcnt(4)
    v_mfma_f32_16x16x32_bf16 v[56:59], v[48:51], v[20:23], v[56:59]
    ds_read_b128 v[48:51], v7 offset:13312
    s_waitcnt lgkmcnt(4)
    v_mfma_f32_16x16x32_bf16 v[56:59], v[52:55], v[24:27], v[56:59]
    ds_read_b128 v[52:55], v7 offset:14336
    s_waitcnt lgkmcnt(4)
    v_mfma_f32_16x16x32_bf16 v[56:59], v[36:39], v[28:31], v[56:59]
    ds_read_b128 v[36:39], v7 offset:15360
    s_waitcnt lgkmcnt(4)
    v_mfma_f32_16x16x32_bf16 v[56:59], v[40:43], v[32:35], v[56:59]
    s_nop 7
    s_nop 1
    v_min_u32 v56, -2, v56
    v_min_u32 v57, -2, v57
    v_min_u32 v58, -2, v58
    v_min_u32 v59, -2, v59
    buffer_store_dwordx4 v[56:59], v0, s[8:11], s32 offen
    v_add_u32 v0, 0x4000, v0
    v_mov_b32 v60, 0
    v_mov_b32 v61, 0
    v_mov_b32 v62, 0
    v_mov_b32 v63, 0
    s_waitcnt lgkmcnt(3)
    v_mfma_f32_16x16x32_bf16 v[60:63], v[44:47], v[20:23], v[60:63]
    s_waitcnt lgkmcnt(2)
    v_mfma_f32_16x16x32_bf16 v[60:63], v[48:51], v[24:27], v[60:63]
    s_waitcnt lgkmcnt(1)
    v_mfma_f32_16x16x32_bf16 v[60:63], v[52:55], v[28:31], v[60:63]
    s_waitcnt lgkmcnt(0)
    v_mfma_f32_16x16x32_bf16 v[60:63], v[36:39], v[32:35], v[60:63]
    s_nop 7
    s_nop 1
    v_min_u32 v60, -2, v60
    v_min_u32 v61, -2, v61
    v_min_u32 v62, -2, v62
    v_min_u32 v63, -2, v63
    buffer_store_dwordx4 v[60:63], v0, s[8:11], s32 offen
    v_add_u32 v0, 0x4000, v0
    s_cmp_ge_u32 s20, 4
    s_cbranch_scc1 .g533
    s_add_u32 s34, s34, 0x80000
    s_add_u32 s35, s35, 64
    s_add_u32 s21, s30, 1
    s_and_b32 s22, s21, 3
    s_cmp_lg_u32 s22, 0
    s_cbranch_scc1 .nk35
    s_lshl_b32 s21, s21, 5
    s_lshl_b32 s22, s2, 2
    s_add_u32 s21, s21, s22
    s_add_u32 s21, s21, 0x7100000
    v_mov_b32 v36, s21
    s_mov_b32 s37, 0
.wf36:
    buffer_load_dword v37, v36, s[8:11], 0 offen sc1
    s_waitcnt vmcnt(0)
    v_readfirstlane_b32 s38, v37
    s_add_u32 s37, s37, 1
    s_cmp_lg_u32 s38, 0
    s_cbranch_scc1 .wfd37
    s_sleep 2
    s_cmp_lt_u32 s37, 1048576
    s_cbranch_scc1 .wf36
.wfd37:
.nk35:
    s_lshl_b32 s21, s20, 11
    s_add_u32 s21, s21, 8192
    s_mov_b32 m0, s21
    s_nop 0
    buffer_load_dwordx4 v15, s[8:11], s34 offen sc1 lds
    s_add_u32 s21, s21, 1024
    s_mov_b32 m0, s21
    v_add_u32 v0, 64, v15
    buffer_load_dwordx4 v0, s[8:11], s34 offen sc1 lds
    s_lshl_b32 s21, s20, 10
    s_add_u32 s21, s21, 24576
    s_mov_b32 m0, s21
    s_nop 0
    buffer_load_dwordx4 v16, s[8:11], s35 offen sc1 lds
    s_add_u32 s21, s21, 4096
    s_mov_b32 m0, s21
    v_add_u32 v0, 0x40000, v16
    buffer_load_dwordx4 v0, s[8:11], s35 offen sc1 lds
    s_branch .b434
.g533:
    s_add_u32 s60, s32, 0
    s_add_u32 s61, s32, 4096
    s_add_u32 s62, s32, 8192
    s_add_u32 s63, s32, 12288
    s_mov_b32 s36, 0
    buffer_load_dwordx4 v[20:23], v11, s[8:11], s60 offen sc1
    buffer_load_dwordx4 v[24:27], v11, s[8:11], s61 offen sc1
    buffer_load_dwordx4 v[28:31], v11, s[8:11], s62 offen sc1
    buffer_load_dwordx4 v[32:35], v11, s[8:11], s63 offen sc1
.p138:
    buffer_load_dwordx4 v[36:39], v11, s[8:11], s60 offen sc1
    buffer_load_dwordx4 v[40:43], v11, s[8:11], s61 offen sc1
    buffer_load_dwordx4 v[44:47], v11, s[8:11], s62 offen sc1
    buffer_load_dwordx4 v[48:51], v11, s[8:11], s63 offen sc1
    s_waitcnt vmcnt(4)
    v_max_u32 v52, v20, v21
    v_max3_u32 v52, v52, v22, v23
    v_max3_u32 v52, v52, v24, v25
    v_max3_u32 v52, v52, v26, v27
    v_max3_u32 v52, v52, v28, v29
    v_max3_u32 v52, v52, v30, v31
    v_max3_u32 v52, v52, v32, v33
    v_max3_u32 v52, v52, v34, v35
    v_cmp_ne_u32 vcc, -1, v52
    s_cmp_eq_u64 vcc, exec
    s_cbranch_scc1 .p1a39
    buffer_load_dwordx4 v[20:23], v11, s[8:11], s60 offen sc1
    buffer_load_dwordx4 v[24:27], v11, s[8:11], s61 offen sc1
    buffer_load_dwordx4 v[28:31], v11, s[8:11], s62 offen sc1
    buffer_load_dwordx4 v[32:35], v11, s[8:11], s63 offen sc1
    s_waitcnt vmcnt(4)
    v_max_u32 v52, v36, v37
    v_max3_u32 v52, v52, v38, v39
    v_max3_u32 v52, v52, v40, v41
    v_max3_u32 v52, v52, v42, v43
    v_max3_u32 v52, v52, v44, v45
    v_max3_u32 v52, v52, v46, v47
    v_max3_u32 v52, v52, v48, v49
    v_max3_u32 v52, v52, v50, v51
    v_cmp_ne_u32 vcc, -1, v52
    s_cmp_eq_u64 vcc, exec
    s_cbranch_scc1 .p1b40
    s_add_u32 s36, s36, 1
    s_cmp_lt_u32 s36, 131072
    s_cbranch_scc1 .p138
    s_branch .p1a39
.p1b40:
    v_add_f32 v52, v36, v40
    v_add_f32 v56, v44, v48
    v_add_f32 v53, v37, v41
    v_add_f32 v57, v45, v49
    v_add_f32 v54, v38, v42
    v_add_f32 v58, v46, v50
    v_add_f32 v55, v39, v43
    v_add_f32 v59, v47, v51
    v_add_f32 v52, v52, v56
    v_add_f32 v53, v53, v57
    v_add_f32 v54, v54, v58
    v_add_f32 v55, v55, v59
    s_branch .p1j41
.p1a39:
    v_add_f32 v52, v20, v24
    v_add_f32 v56, v28, v32
    v_add_f32 v53, v21, v25
    v_add_f32 v57, v29, v33
    v_add_f32 v54, v22, v26
    v_add_f32 v58, v30, v34
    v_add_f32 v55, v23, v27
    v_add_f32 v59, v31, v35
    v_add_f32 v52, v52, v56
    v_add_f32 v53, v53, v57
    v_add_f32 v54, v54, v58
    v_add_f32 v55, v55, v59
.p1j41:
    s_nop 1
    v_add_f32_dpp v56, v52, v52 row_ror:8 row_mask:0xf bank_mask:0xf
    v_add_f32_dpp v57, v53, v53 row_ror:8 row_mask:0xf bank_mask:0xf
    v_add_f32_dpp v58, v54, v54 row_ror:8 row_mask:0xf bank_mask:0xf
    v_add_f32_dpp v59, v55, v55 row_ror:8 row_mask:0xf bank_mask:0xf
    v_mov_b32 v52, v56
    v_mov_b32 v53, v57
    v_mov_b32 v54, v58
    v_mov_b32 v55, v59
    s_nop 1
    v_permlane16_swap_b32 v52, v56
    v_permlane16_swap_b32 v53, v57
    v_permlane16_swap_b32 v54, v58
    v_permlane16_swap_b32 v55, v59
    s_nop 1
    v_add_f32 v52, v52, v56
    v_add_f32 v53, v53, v57
    v_add_f32 v54, v54, v58
    v_add_f32 v55, v55, v59
    v_mov_b32 v56, v52
    v_mov_b32 v57, v53
    v_mov_b32 v58, v54
    v_mov_b32 v59, v55
    s_nop 1
    v_permlane32_swap_b32 v52, v56
    v_permlane32_swap_b32 v53, v57
    v_permlane32_swap_b32 v54, v58
    v_permlane32_swap_b32 v55, v59
    s_nop 1
    v_add_f32 v52, v52, v56
    v_add_f32 v53, v53, v57
    v_add_f32 v54, v54, v58
    v_add_f32 v55, v55, v59
    v_cvt_pk_bf16_f32 v56, v52, v53
    v_cvt_pk_bf16_f32 v57, v54, v55
    v_min_u32 v56, -2, v56
    v_min_u32 v57, -2, v57
    buffer_store_dwordx2 v[56:57], v17, s[8:11], s31 offen
.b434:
    s_add_u32 s30, s30, 1
    s_add_u32 s31, s31, 8192
    s_add_u32 s32, s32, 0x80000
    s_add_u32 s33, s33, 0x10000
    s_branch .step20

.last28:
    v_mov_b32 v44, 0
    v_mov_b32 v45, 0
    v_mov_b32 v46, 0
    v_mov_b32 v47, 0
    ds_read_b128 v[20:23], v4
    ds_read_b128 v[24:27], v4 offset:512
    ds_read_b128 v[28:31], v4 offset:1024
    ds_read_b128 v[32:35], v4 offset:1536
    s_waitcnt lgkmcnt(3)
    v_mfma_f32_16x16x32_bf16 v[44:47], v[20:23], v[192:195], v[44:47]
    ds_read_b128 v[20:23], v4 offset:2048
    s_waitcnt lgkmcnt(3)
    v_mfma_f32_16x16x32_bf16 v[44:47], v[24:27], v[196:199], v[44:47]
    ds_read_b128 v[24:27], v4 offset:2560
    s_waitcnt lgkmcnt(3)
    v_mfma_f32_16x16x32_bf16 v[44:47], v[28:31], v[200:203], v[44:47]
    ds_read_b128 v[28:31], v4 offset:3072
    s_waitcnt lgkmcnt(3)
    v_mfma_f32_16x16x32_bf16 v[44:47], v[32:35], v[204:207], v[44:47]
    ds_read_b128 v[32:35], v4 offset:3584
    s_waitcnt lgkmcnt(3)
    v_mfma_f32_16x16x32_bf16 v[44:47], v[20:23], v[208:211], v[44:47]
    ds_read_b128 v[20:23], v4 offset:4096
    s_waitcnt lgkmcnt(3)
    v_mfma_f32_16x16x32_bf16 v[44:47], v[24:27], v[212:215], v[44:47]
    ds_read_b128 v[24:27], v4 offset:4608
    s_waitcnt lgkmcnt(3)
    v_mfma_f32_16x16x32_bf16 v[44:47], v[28:31], v[216:219], v[44:47]
    ds_read_b128 v[28:31], v4 offset:5120
    s_waitcnt lgkmcnt(3)
    v_mfma_f32_16x16x32_bf16 v[44:47], v[32:35], v[220:223], v[44:47]
    ds_read_b128 v[32:35], v4 offset:5632
    s_waitcnt lgkmcnt(3)
    v_mfma_f32_16x16x32_bf16 v[44:47], v[20:23], v[224:227], v[44:47]
    ds_read_b128 v[20:23], v4 offset:6144
    s_waitcnt lgkmcnt(3)
    v_mfma_f32_16x16x32_bf16 v[44:47], v[24:27], v[228:231], v[44:47]
    ds_read_b128 v[24:27], v4 offset:6656
    s_waitcnt lgkmcnt(3)
    v_mfma_f32_16x16x32_bf16 v[44:47], v[28:31], v[232:235], v[44:47]
    ds_read_b128 v[28:31], v4 offset:7168
    s_waitcnt lgkmcnt(3)
    v_mfma_f32_16x16x32_bf16 v[44:47], v[32:35], v[236:239], v[44:47]
    ds_read_b128 v[32:35], v4 offset:7680
    s_waitcnt lgkmcnt(3)
    v_mfma_f32_16x16x32_bf16 v[44:47], v[20:23], v[240:243], v[44:47]
    s_waitcnt lgkmcnt(2)
    v_mfma_f32_16x16x32_bf16 v[44:47], v[24:27], v[244:247], v[44:47]
    s_waitcnt lgkmcnt(1)
    v_mfma_f32_16x16x32_bf16 v[44:47], v[28:31], v[248:251], v[44:47]
    s_waitcnt lgkmcnt(0)
    v_mfma_f32_16x16x32_bf16 v[44:47], v[32:35], v[252:255], v[44:47]
    s_nop 7
    s_nop 1
    v_cvt_pk_bf16_f32 v18, v44, v45
    v_cvt_pk_bf16_f32 v19, v46, v47
    buffer_store_dwordx2 v[18:19], v14, s[8:11], s33 offen sc1
    s_waitcnt vmcnt(0)
    s_barrier
    s_cmp_lg_u32 s20, 5
    s_cbranch_scc1 .mend12
    s_lshl_b32 s22, s2, 2
    s_add_u32 s21, s22, 0x7103f80
    v_mov_b32 v36, s21
    v_mov_b32 v37, 1
    s_mov_b64 exec, 1
    buffer_store_dword v37, v36, s[8:11], 0 offen sc1
    v_subrev_u32 v36, 128, v36
    buffer_store_dword v37, v36, s[8:11], 0 offen sc1
    s_branch .mend12
.slow16:
    s_cmp_ge_u32 s20, 4
    s_cbranch_scc1 .ip42
    s_lshl_b32 s21, s2, 2
    s_add_u32 s21, s21, 0x7100000
    v_mov_b32 v20, s21
    s_mov_b32 s37, 0
.wf43:
    buffer_load_dword v21, v20, s[8:11], 0 offen sc1
    s_waitcnt vmcnt(0)
    v_readfirstlane_b32 s38, v21
    s_add_u32 s37, s37, 1
    s_cmp_lg_u32 s38, 0
    s_cbranch_scc1 .wfd44
    s_sleep 2
    s_cmp_lt_u32 s37, 1048576
    s_cbranch_scc1 .wf43
.wfd44:
    s_lshl_b32 s21, s20, 11
    s_add_u32 s21, s21, 8192
    s_mov_b32 m0, s21
    s_nop 0
    buffer_load_dwordx4 v15, s[8:11], s34 offen sc1 lds
    s_add_u32 s21, s21, 1024
    s_mov_b32 m0, s21
    v_add_u32 v0, 64, v15
    buffer_load_dwordx4 v0, s[8:11], s34 offen sc1 lds
    s_lshl_b32 s21, s20, 10
    s_add_u32 s21, s21, 24576
    s_mov_b32 m0, s21
    s_nop 0
    buffer_load_dwordx4 v16, s[8:11], s35 offen sc1 lds
    s_add_u32 s21, s21, 4096
    s_mov_b32 m0, s21
    v_add_u32 v0, 0x40000, v16
    buffer_load_dwordx4 v0, s[8:11], s35 offen sc1 lds
.ip42:
.step45:
    s_cmp_ge_u32 s20, 4
    s_cbranch_scc1 .g146
    s_branch .b147
.g146:
    s_mov_b32 s36, 0
    buffer_load_dwordx4 v[20:23], v8, s[8:11], s31 offen sc1
    buffer_load_dwordx4 v[24:27], v8, s[8:11], s31 offen offset:1024 sc1
.p248:
    buffer_load_dwordx4 v[28:31], v8, s[8:11], s31 offen sc1
    buffer_load_dwordx4 v[32:35], v8, s[8:11], s31 offen offset:1024 sc1
    s_waitcnt vmcnt(2)
    v_max_u32 v36, v20, v21
    v_max3_u32 v36, v36, v22, v23
    v_max3_u32 v36, v36, v24, v25
    v_max3_u32 v36, v36, v26, v27
    v_cmp_ne_u32 vcc, -1, v36
    s_cmp_eq_u64 vcc, exec
    s_cbranch_scc1 .p2a49
    buffer_load_dwordx4 v[20:23], v8, s[8:11], s31 offen sc1
    buffer_load_dwordx4 v[24:27], v8, s[8:11], s31 offen offset:1024 sc1
    s_waitcnt vmcnt(2)
    v_max_u32 v36, v28, v29
    v_max3_u32 v36, v36, v30, v31
    v_max3_u32 v36, v36, v32, v33
    v_max3_u32 v36, v36, v34, v35
    v_cmp_ne_u32 vcc, -1, v36
    s_cmp_eq_u64 vcc, exec
    s_cbranch_scc1 .p2b50
    s_add_u32 s36, s36, 1
    s_cmp_lt_u32 s36, 131072
    s_cbranch_scc1 .p248
    s_branch .p2a49
.p2b50:
    ds_write_b128 v9, v[28:31]
    ds_write_b128 v9, v[32:35] offset:1024
    s_branch .p2j51
.p2a49:
    ds_write_b128 v9, v[20:23]
    ds_write_b128 v9, v[24:27] offset:1024
.p2j51:
    s_waitcnt vmcnt(0)
.b147:
    s_waitcnt lgkmcnt(0)
    s_barrier
    s_cmp_lt_u32 s20, 4
    s_cbranch_scc1 .wm252
    buffer_load_dword v62, v12, s[8:11], s32 offen sc1
    s_add_u32 s21, s31, 8192
    v_lshlrev_b32 v0, 4, v1
    v_sub_u32 v0, v8, v0
    v_lshl_add_u32 v0, v1, 5, v0
    buffer_load_dword v63, v0, s[8:11], s21 offen sc1
.wm252:
    v_mov_b32 v36, 0
    v_mov_b32 v37, 0
    v_mov_b32 v38, 0
    v_mov_b32 v39, 0
    v_mov_b32 v40, 0
    v_mov_b32 v41, 0
    v_mov_b32 v42, 0
    v_mov_b32 v43, 0
    ds_read_b128 v[20:23], v4
    ds_read_b128 v[24:27], v4 offset:512
    ds_read_b128 v[28:31], v4 offset:1024
    ds_read_b128 v[32:35], v4 offset:1536
    s_waitcnt lgkmcnt(3)
    v_mfma_f32_16x16x32_bf16 v[36:39], v[64:67], v[20:23], v[36:39]
    v_mfma_f32_16x16x32_bf16 v[40:43], v[128:131], v[20:23], v[40:43]
    ds_read_b128 v[20:23], v4 offset:2048
    s_waitcnt lgkmcnt(3)
    v_mfma_f32_16x16x32_bf16 v[36:39], v[68:71], v[24:27], v[36:39]
    v_mfma_f32_16x16x32_bf16 v[40:43], v[132:135], v[24:27], v[40:43]
    ds_read_b128 v[24:27], v4 offset:2560
    s_waitcnt lgkmcnt(3)
    v_mfma_f32_16x16x32_bf16 v[36:39], v[72:75], v[28:31], v[36:39]
    v_mfma_f32_16x16x32_bf16 v[40:43], v[136:139], v[28:31], v[40:43]
    ds_read_b128 v[28:31], v4 offset:3072
    s_waitcnt lgkmcnt(3)
    v_mfma_f32_16x16x32_bf16 v[36:39], v[76:79], v[32:35], v[36:39]
    v_mfma_f32_16x16x32_bf16 v[40:43], v[140:143], v[32:35], v[40:43]
    ds_read_b128 v[32:35], v4 offset:3584
    s_waitcnt lgkmcnt(3)
    v_mfma_f32_16x16x32_bf16 v[36:39], v[80:83], v[20:23], v[36:39]
    v_mfma_f32_16x16x32_bf16 v[40:43], v[144:147], v[20:23], v[40:43]
    ds_read_b128 v[20:23], v4 offset:4096
    s_waitcnt lgkmcnt(3)
    v_mfma_f32_16x16x32_bf16 v[36:39], v[84:87], v[24:27], v[36:39]
    v_mfma_f32_16x16x32_bf16 v[40:43], v[148:151], v[24:27], v[40:43]
    ds_read_b128 v[24:27], v4 offset:4608
    s_waitcnt lgkmcnt(3)
    v_mfma_f32_16x16x32_bf16 v[36:39], v[88:91], v[28:31], v[36:39]
    v_mfma_f32_16x16x32_bf16 v[40:43], v[152:155], v[28:31], v[40:43]
    ds_read_b128 v[28:31], v4 offset:5120
    s_waitcnt lgkmcnt(3)
    v_mfma_f32_16x16x32_bf16 v[36:39], v[92:95], v[32:35], v[36:39]
    v_mfma_f32_16x16x32_bf16 v[40:43], v[156:159], v[32:35], v[40:43]
    ds_read_b128 v[32:35], v4 offset:5632
    s_waitcnt lgkmcnt(3)
    v_mfma_f32_16x16x32_bf16 v[36:39], v[96:99], v[20:23], v[36:39]
    v_mfma_f32_16x16x32_bf16 v[40:43], v[160:163], v[20:23], v[40:43]
    ds_read_b128 v[20:23], v4 offset:6144
    s_waitcnt lgkmcnt(3)
    v_mfma_f32_16x16x32_bf16 v[36:39], v[100:103], v[24:27], v[36:39]
    v_mfma_f32_16x16x32_bf16 v[40:43], v[164:167], v[24:27], v[40:43]
    ds_read_b128 v[24:27], v4 offset:6656
    s_waitcnt lgkmcnt(3)
    v_mfma_f32_16x16x32_bf16 v[36:39], v[104:107], v[28:31], v[36:39]
    v_mfma_f32_16x16x32_bf16 v[40:43], v[168:171], v[28:31], v[40:43]
    ds_read_b128 v[28:31], v4 offset:7168
    s_waitcnt lgkmcnt(3)
    v_mfma_f32_16x16x32_bf16 v[36:39], v[108:111], v[32:35], v[36:39]
    v_mfma_f32_16x16x32_bf16 v[40:43], v[172:175], v[32:35], v[40:43]
    ds_read_b128 v[32:35], v4 offset:7680
    s_waitcnt lgkmcnt(3)
    v_mfma_f32_16x16x32_bf16 v[36:39], v[112:115], v[20:23], v[36:39]
    v_mfma_f32_16x16x32_bf16 v[40:43], v[176:179], v[20:23], v[40:43]
    s_waitcnt lgkmcnt(2)
    v_mfma_f32_16x16x32_bf16 v[36:39], v[116:119], v[24:27], v[36:39]
    v_mfma_f32_16x16x32_bf16 v[40:43], v[180:183], v[24:27], v[40:43]
    s_waitcnt lgkmcnt(1)
    v_mfma_f32_16x16x32_bf16 v[36:39], v[120:123], v[28:31], v[36:39]
    v_mfma_f32_16x16x32_bf16 v[40:43], v[184:187], v[28:31], v[40:43]
    s_waitcnt lgkmcnt(0)
    v_mfma_f32_16x16x32_bf16 v[36:39], v[124:127], v[32:35], v[36:39]
    v_mfma_f32_16x16x32_bf16 v[40:43], v[188:191], v[32:35], v[40:43]
    s_nop 7
    s_nop 1
    v_cvt_pk_bf16_f32 v20, v36, v37
    v_cvt_pk_bf16_f32 v21, v38, v39
    v_cvt_pk_bf16_f32 v22, v40, v41
    v_cvt_pk_bf16_f32 v23, v42, v43

    ds_write_b64 v6, v[20:21] offset:16384
    ds_write_b64 v6, v[22:23] offset:18432
    buffer_store_dwordx2 v[22:23], v13, s[8:11], s33 offen sc1
    s_cmp_eq_u32 s30, 63
    s_cbranch_scc1 .last53
    s_cmp_ge_u32 s20, 4
    s_cbranch_scc1 .nw254
    s_waitcnt vmcnt(1)
.nw254:
    s_waitcnt lgkmcnt(0)
    s_barrier
    s_cmp_lg_u32 s20, 5
    s_cbranch_scc1 .nf55
    s_cmp_eq_u32 s30, 0
    s_cbranch_scc1 .nf55
    s_lshl_b32 s21, s30, 7
    s_lshl_b32 s22, s2, 2
    s_add_u32 s21, s21, s22
    s_add_u32 s21, s21, 0x7101f80
    v_mov_b32 v36, s21
    v_mov_b32 v37, 1
    s_mov_b64 s[54:55], exec
    s_mov_b64 exec, 1
    buffer_store_dword v37, v36, s[8:11], 0 offen sc1
    s_mov_b64 exec, s[54:55]
.nf55:
    s_cmp_lt_u32 s20, 4
    s_cbranch_scc1 .p357
    v_mov_b32 v44, 0
    v_mov_b32 v45, 0
    v_mov_b32 v46, 0
    v_mov_b32 v47, 0
    ds_read_b128 v[20:23], v4
    ds_read_b128 v[24:27], v4 offset:512
    ds_read_b128 v[28:31], v4 offset:1024
    ds_read_b128 v[32:35], v4 offset:1536
    s_waitcnt lgkmcnt(3)
    v_mfma_f32_16x16x32_bf16 v[44:47], v[20:23], v[192:195], v[44:47]
    ds_read_b128 v[20:23], v4 offset:2048
    s_waitcnt lgkmcnt(3)
    v_mfma_f32_16x16x32_bf16 v[44:47], v[24:27], v[196:199], v[44:47]
    ds_read_b128 v[24:27], v4 offset:2560
    s_waitcnt lgkmcnt(3)
    v_mfma_f32_16x16x32_bf16 v[44:47], v[28:31], v[200:203], v[44:47]
    ds_read_b128 v[28:31], v4 offset:3072
    s_waitcnt lgkmcnt(3)
    v_mfma_f32_16x16x32_bf16 v[44:47], v[32:35], v[204:207], v[44:47]
    ds_read_b128 v[32:35], v4 offset:3584
    s_waitcnt lgkmcnt(3)
    v_mfma_f32_16x16x32_bf16 v[44:47], v[20:23], v[208:211], v[44:47]
    ds_read_b128 v[20:23], v4 offset:4096
    s_waitcnt lgkmcnt(3)
    v_mfma_f32_16x16x32_bf16 v[44:47], v[24:27], v[212:215], v[44:47]
    ds_read_b128 v[24:27], v4 offset:4608
    s_waitcnt lgkmcnt(3)
    v_mfma_f32_16x16x32_bf16 v[44:47], v[28:31], v[216:219], v[44:47]
    ds_read_b128 v[28:31], v4 offset:5120
    s_waitcnt lgkmcnt(3)
    v_mfma_f32_16x16x32_bf16 v[44:47], v[32:35], v[220:223], v[44:47]
    ds_read_b128 v[32:35], v4 offset:5632
    s_waitcnt lgkmcnt(3)
    v_mfma_f32_16x16x32_bf16 v[44:47], v[20:23], v[224:227], v[44:47]
    ds_read_b128 v[20:23], v4 offset:6144
    s_waitcnt lgkmcnt(3)
    v_mfma_f32_16x16x32_bf16 v[44:47], v[24:27], v[228:231], v[44:47]
    ds_read_b128 v[24:27], v4 offset:6656
    s_waitcnt lgkmcnt(3)
    v_mfma_f32_16x16x32_bf16 v[44:47], v[28:31], v[232:235], v[44:47]
    ds_read_b128 v[28:31], v4 offset:7168
    s_waitcnt lgkmcnt(3)
    v_mfma_f32_16x16x32_bf16 v[44:47], v[32:35], v[236:239], v[44:47]
    ds_read_b128 v[32:35], v4 offset:7680
    s_waitcnt lgkmcnt(3)
    v_mfma_f32_16x16x32_bf16 v[44:47], v[20:23], v[240:243], v[44:47]
    s_waitcnt lgkmcnt(2)
    v_mfma_f32_16x16x32_bf16 v[44:47], v[24:27], v[244:247], v[44:47]
    s_waitcnt lgkmcnt(1)
    v_mfma_f32_16x16x32_bf16 v[44:47], v[28:31], v[248:251], v[44:47]
    s_waitcnt lgkmcnt(0)
    v_mfma_f32_16x16x32_bf16 v[44:47], v[32:35], v[252:255], v[44:47]
    s_nop 7
    s_nop 1
    v_cvt_pk_bf16_f32 v18, v44, v45
    v_cvt_pk_bf16_f32 v19, v46, v47
    s_lshl_b32 s21, s20, 9
    v_lshl_add_u32 v0, v1, 3, s21
    ds_write_b64 v0, v[18:19] offset:20480
    buffer_store_dwordx2 v[18:19], v14, s[8:11], s33 offen sc1
    s_waitcnt lgkmcnt(0)
    s_barrier
    s_branch .sk356
.p357:
    ds_read_b128 v[20:23], v5 offset:16384
    ds_read_b128 v[24:27], v5 offset:16896
    ds_read_b128 v[28:31], v5 offset:17408
    ds_read_b128 v[32:35], v5 offset:17920
    v_lshlrev_b32 v0, 4, v1
    ds_read_b128 v[48:51], v5 offset:18432
    ds_read_b128 v[52:55], v5 offset:18944
    ds_read_b128 v[56:59], v5 offset:19456
    v_mov_b32 v36, 0
    v_mov_b32 v37, 0
    v_mov_b32 v38, 0
    v_mov_b32 v39, 0
    v_mov_b32 v40, 0
    v_mov_b32 v41, 0
    v_mov_b32 v42, 0
    v_mov_b32 v43, 0
    v_mov_b32 v44, 0
    v_mov_b32 v45, 0
    v_mov_b32 v46, 0
    v_mov_b32 v47, 0
    ds_read_b128 v[60:63], v5 offset:19968
    s_waitcnt lgkmcnt(3)
    v_mfma_f32_16x16x32_bf16 v[36:39], v[48:51], v[20:23], v[36:39]
    ds_read_b128 v[48:51], v0 offset:8192
    s_waitcnt lgkmcnt(3)
    v_mfma_f32_16x16x32_bf16 v[36:39], v[52:55], v[24:27], v[36:39]
    ds_read_b128 v[52:55], v0 offset:9216
    s_waitcnt lgkmcnt(3)
    v_mfma_f32_16x16x32_bf16 v[36:39], v[56:59], v[28:31], v[36:39]
    ds_read_b128 v[56:59], v0 offset:10240
    s_waitcnt lgkmcnt(3)
    v_mfma_f32_16x16x32_bf16 v[36:39], v[60:63], v[32:35], v[36:39]
    ds_read_b128 v[60:63], v0 offset:11264
    s_waitcnt lgkmcnt(3)
    v_mfma_f32_16x16x32_bf16 v[40:43], v[48:51], v[20:23], v[40:43]
    ds_read_b128 v[48:51], v0 offset:12288
    s_waitcnt lgkmcnt(3)
    v_mfma_f32_16x16x32_bf16 v[40:43], v[52:55], v[24:27], v[40:43]
    ds_read_b128 v[52:55], v0 offset:13312
    s_waitcnt lgkmcnt(3)
    v_mfma_f32_16x16x32_bf16 v[40:43], v[56:59], v[28:31], v[40:43]
    ds_read_b128 v[56:59], v0 offset:14336
    s_waitcnt lgkmcnt(3)
    v_mfma_f32_16x16x32_bf16 v[40:43], v[60:63], v[32:35], v[40:43]
    ds_read_b128 v[60:63], v0 offset:15360
    s_waitcnt lgkmcnt(3)
    v_mfma_f32_16x16x32_bf16 v[44:47], v[48:51], v[20:23], v[44:47]
    s_waitcnt lgkmcnt(2)
    v_mfma_f32_16x16x32_bf16 v[44:47], v[52:55], v[24:27], v[44:47]
    s_waitcnt lgkmcnt(1)
    v_mfma_f32_16x16x32_bf16 v[44:47], v[56:59], v[28:31], v[44:47]
    s_waitcnt lgkmcnt(0)
    v_mfma_f32_16x16x32_bf16 v[44:47], v[60:63], v[32:35], v[44:47]
    ds_read_b128 v[48:51], v4 offset:0
    ds_read_b128 v[52:55], v4 offset:512
    ds_read_b128 v[56:59], v4 offset:1024
    ds_read_b128 v[60:63], v4 offset:1536
    v_mov_b32 v24, 0
    v_mov_b32 v25, 0
    v_mov_b32 v26, 0
    v_mov_b32 v27, 0
    s_nop 4
    v_cvt_pk_bf16_f32 v20, v36, v37
    v_lshlrev_b32 v36, 16, v20
    v_and_b32 v37, 0xffff0000, v20
    v_mul_f32 v36, 0x3db504f3, v36
    v_mul_f32 v37, 0x3db504f3, v37
    v_cvt_pk_bf16_f32 v20, v36, v37
    v_lshlrev_b32 v36, 16, v20
    v_and_b32 v37, 0xffff0000, v20
    s_waitcnt lgkmcnt(3)
    v_mfma_f32_16x16x32_bf16 v[24:27], v[48:51], v[192:195], v[24:27]
    ds_read_b128 v[48:51], v4 offset:2048
    v_cvt_pk_bf16_f32 v20, v38, v39
    v_lshlrev_b32 v38, 16, v20
    v_and_b32 v39, 0xffff0000, v20
    v_mul_f32 v38, 0x3db504f3, v38
    v_mul_f32 v39, 0x3db504f3, v39
    v_cvt_pk_bf16_f32 v20, v38, v39
    v_lshlrev_b32 v38, 16, v20
    v_and_b32 v39, 0xffff0000, v20
    s_waitcnt lgkmcnt(3)
    v_mfma_f32_16x16x32_bf16 v[24:27], v[52:55], v[196:199], v[24:27]
    ds_read_b128 v[52:55], v4 offset:2560
    v_cvt_pk_bf16_f32 v20, v40, v41
    v_lshlrev_b32 v40, 16, v20
    v_and_b32 v41, 0xffff0000, v20
    v_mul_f32 v40, 0x3db504f3, v40
    v_mul_f32 v41, 0x3db504f3, v41
    v_cvt_pk_bf16_f32 v20, v40, v41
    v_lshlrev_b32 v40, 16, v20
    v_and_b32 v41, 0xffff0000, v20
    s_waitcnt lgkmcnt(3)
    v_mfma_f32_16x16x32_bf16 v[24:27], v[56:59], v[200:203], v[24:27]
    ds_read_b128 v[56:59], v4 offset:3072
    v_cvt_pk_bf16_f32 v20, v42, v43
    v_lshlrev_b32 v42, 16, v20
    v_and_b32 v43, 0xffff0000, v20
    v_mul_f32 v42, 0x3db504f3, v42
    v_mul_f32 v43, 0x3db504f3, v43
    v_cvt_pk_bf16_f32 v20, v42, v43
    v_lshlrev_b32 v42, 16, v20
    v_and_b32 v43, 0xffff0000, v20
    s_waitcnt lgkmcnt(3)
    v_mfma_f32_16x16x32_bf16 v[24:27], v[60:63], v[204:207], v[24:27]
    ds_read_b128 v[60:63], v4 offset:3584
    v_cvt_pk_bf16_f32 v20, v44, v45
    v_lshlrev_b32 v44, 16, v20
    v_and_b32 v45, 0xffff0000, v20
    v_mul_f32 v44, 0x3db504f3, v44
    v_mul_f32 v45, 0x3db504f3, v45
    v_cvt_pk_bf16_f32 v20, v44, v45
    v_lshlrev_b32 v44, 16, v20
    v_and_b32 v45, 0xffff0000, v20
    s_waitcnt lgkmcnt(3)
    v_mfma_f32_16x16x32_bf16 v[24:27], v[48:51], v[208:211], v[24:27]
    ds_read_b128 v[48:51], v4 offset:4096
    v_cvt_pk_bf16_f32 v20, v46, v47
    v_lshlrev_b32 v46, 16, v20
    v_and_b32 v47, 0xffff0000, v20
    v_mul_f32 v46, 0x3db504f3, v46
    v_mul_f32 v47, 0x3db504f3, v47
    v_cvt_pk_bf16_f32 v20, v46, v47
    v_lshlrev_b32 v46, 16, v20
    v_and_b32 v47, 0xffff0000, v20
    s_waitcnt lgkmcnt(3)
    v_mfma_f32_16x16x32_bf16 v[24:27], v[52:55], v[212:215], v[24:27]
    ds_read_b128 v[52:55], v4 offset:4608
    v_mov_b32 v20, 0xff800000
    v_cndmask_b32 v36, v20, v36, s[40:41]
    v_cndmask_b32 v37, v20, v37, s[40:41]
    v_cndmask_b32 v38, v20, v38, s[40:41]
    v_cndmask_b32 v39, v20, v39, s[40:41]
    v_max_f32 v21, v36, v37
    v_max_f32 v21, v21, v38
    v_max_f32 v21, v21, v39
    s_waitcnt lgkmcnt(3)
    v_mfma_f32_16x16x32_bf16 v[24:27], v[56:59], v[216:219], v[24:27]
    ds_read_b128 v[56:59], v4 offset:5120
    v_max_f32 v21, v21, v40
    v_max_f32 v21, v21, v41
    v_max_f32 v21, v21, v42
    v_max_f32 v21, v21, v43
    v_max_f32 v21, v21, v44
    v_max_f32 v21, v21, v45
    v_max_f32 v21, v21, v46
    v_max_f32 v21, v21, v47
    s_waitcnt lgkmcnt(3)
    v_mfma_f32_16x16x32_bf16 v[24:27], v[60:63], v[220:223], v[24:27]
    ds_read_b128 v[60:63], v4 offset:5632
    v_mov_b32 v23, v21
    s_nop 1
    v_permlane16_swap_b32 v21, v23
    s_nop 1
    v_max_f32 v21, v21, v23
    v_mov_b32 v23, v21
    s_nop 1
    v_permlane32_swap_b32 v21, v23
    s_waitcnt lgkmcnt(3)
    v_mfma_f32_16x16x32_bf16 v[24:27], v[48:51], v[224:227], v[24:27]
    ds_read_b128 v[48:51], v4 offset:6144
    s_nop 1
    v_max_f32 v21, v21, v23
    v_sub_f32 v36, v36, v21
    v_mul_f32 v36, 0x3fb8aa3b, v36
    v_exp_f32 v36, v36
    v_sub_f32 v37, v37, v21
    v_mul_f32 v37, 0x3fb8aa3b, v37
    v_exp_f32 v37, v37
    s_waitcnt lgkmcnt(3)
    v_mfma_f32_16x16x32_bf16 v[24:27], v[52:55], v[228:231], v[24:27]
    ds_read_b128 v[52:55], v4 offset:6656
    v_sub_f32 v38, v38, v21
    v_mul_f32 v38, 0x3fb8aa3b, v38
    v_exp_f32 v38, v38
    v_sub_f32 v39, v39, v21
    v_mul_f32 v39, 0x3fb8aa3b, v39
    v_exp_f32 v39, v39
    v_sub_f32 v40, v40, v21
    v_mul_f32 v40, 0x3fb8aa3b, v40
    s_waitcnt lgkmcnt(3)
    v_mfma_f32_16x16x32_bf16 v[24:27], v[56:59], v[232:235], v[24:27]
    ds_read_b128 v[56:59], v4 offset:7168
    v_exp_f32 v40, v40
    v_sub_f32 v41, v41, v21
    v_mul_f32 v41, 0x3fb8aa3b, v41
    v_exp_f32 v41, v41
    v_sub_f32 v42, v42, v21
    v_mul_f32 v42, 0x3fb8aa3b, v42
    v_exp_f32 v42, v42
    v_sub_f32 v43, v43, v21
    s_waitcnt lgkmcnt(3)
    v_mfma_f32_16x16x32_bf16 v[24:27], v[60:63], v[236:239], v[24:27]
    ds_read_b128 v[60:63], v4 offset:7680
    v_mul_f32 v43, 0x3fb8aa3b, v43
    v_exp_f32 v43, v43
    v_sub_f32 v44, v44, v21
    v_mul_f32 v44, 0x3fb8aa3b, v44
    v_exp_f32 v44, v44
    v_sub_f32 v45, v45, v21
    v_mul_f32 v45, 0x3fb8aa3b, v45
    v_exp_f32 v45, v45
    s_waitcnt lgkmcnt(3)
    v_mfma_f32_16x16x32_bf16 v[24:27], v[48:51], v[240:243], v[24:27]
    v_sub_f32 v46, v46, v21
    v_mul_f32 v46, 0x3fb8aa3b, v46
    v_exp_f32 v46, v46
    v_sub_f32 v47, v47, v21
    v_mul_f32 v47, 0x3fb8aa3b, v47
    v_exp_f32 v47, v47
    s_nop 0
    v_add_f32 v22, v36, v37
    s_waitcnt lgkmcnt(2)
    v_mfma_f32_16x16x32_bf16 v[24:27], v[52:55], v[244:247], v[24:27]
    v_add_f32 v22, v22, v38
    v_add_f32 v22, v22, v39
    v_add_f32 v22, v22, v40
    v_add_f32 v22, v22, v41
    v_add_f32 v22, v22, v42
    v_add_f32 v22, v22, v43
    v_add_f32 v22, v22, v44
    v_add_f32 v22, v22, v45
    s_waitcnt lgkmcnt(1)
    v_mfma_f32_16x16x32_bf16 v[24:27], v[56:59], v[248:251], v[24:27]
    v_add_f32 v22, v22, v46
    v_add_f32 v22, v22, v47
    v_mov_b32 v23, v22
    s_nop 1
    v_permlane16_swap_b32 v22, v23
    s_nop 1
    v_add_f32 v22, v22, v23
    v_mov_b32 v23, v22
    s_waitcnt lgkmcnt(0)
    v_mfma_f32_16x16x32_bf16 v[24:27], v[60:63], v[252:255], v[24:27]
    s_nop 1
    v_permlane32_swap_b32 v22, v23
    s_nop 1
    v_add_f32 v22, v22, v23
    v_rcp_f32 v22, v22
    s_nop 0
    v_mul_f32 v36, v36, v22
    v_mul_f32 v37, v37, v22
    v_mul_f32 v38, v38, v22
    v_mul_f32 v39, v39, v22
    v_mul_f32 v40, v40, v22
    v_mul_f32 v41, v41, v22
    v_mul_f32 v42, v42, v22
    v_mul_f32 v43, v43, v22
    v_mul_f32 v44, v44, v22
    v_mul_f32 v45, v45, v22
    v_mul_f32 v46, v46, v22
    v_mul_f32 v47, v47, v22
    v_cvt_pk_bf16_f32 v28, v36, v37
    v_cvt_pk_bf16_f32 v29, v38, v39
    v_cvt_pk_bf16_f32 v30, v40, v41
    v_cvt_pk_bf16_f32 v31, v42, v43
    v_cvt_pk_bf16_f32 v32, v44, v45
    v_cvt_pk_bf16_f32 v33, v46, v47
    s_nop 3
    v_cvt_pk_bf16_f32 v18, v24, v25
    v_cvt_pk_bf16_f32 v19, v26, v27
    buffer_store_dwordx2 v[18:19], v14, s[8:11], s33 offen sc1
    s_barrier
    s_lshl_b32 s21, s20, 9
    v_lshl_add_u32 v0, v1, 3, s21
    ds_read_b64 v[48:49], v0 offset:22528
    s_lshl_b32 s21, s20, 10
    v_lshlrev_b32 v0, 6, v2
    v_lshl_add_u32 v0, v3, 3, v0
    v_add_u32 v0, s21, v0
    ds_read_b64 v[60:61], v0 offset:24576
    ds_read_b64 v[62:63], v0 offset:24608
    ds_read_b64 v[52:53], v0 offset:28672
    ds_read_b64 v[54:55], v0 offset:28704
    v_mov_b32 v36, 0
    v_mov_b32 v37, 0
    v_mov_b32 v38, 0
    v_mov_b32 v39, 0
    v_mov_b32 v40, 0
    v_mov_b32 v41, 0
    v_mov_b32 v42, 0
    v_mov_b32 v43, 0
    s_waitcnt lgkmcnt(0)
    v_mfma_f32_16x16x16_bf16 v[36:39], v[18:19], v[28:29], v[36:39]
    v_mfma_f32_16x16x16_bf16 v[40:43], v[48:49], v[28:29], v[40:43]
    s_nop 7
    v_mfma_f32_16x16x32_bf16 v[36:39], v[60:63], v[30:33], v[36:39]
    v_mfma_f32_16x16x32_bf16 v[40:43], v[52:55], v[30:33], v[40:43]
    s_nop 7
    s_nop 1
    v_cvt_pk_bf16_f32 v20, v36, v37
    v_cvt_pk_bf16_f32 v21, v38, v39
    v_cvt_pk_bf16_f32 v22, v40, v41
    v_cvt_pk_bf16_f32 v23, v42, v43
    ds_write_b64 v6, v[20:21] offset:20480
    ds_write_b64 v6, v[22:23] offset:21504
    s_waitcnt lgkmcnt(0)
.sk356:
    ds_read_b128 v[36:39], v7 offset:0
    ds_read_b128 v[40:43], v7 offset:1024
    ds_read_b128 v[44:47], v7 offset:2048
    ds_read_b128 v[48:51], v7 offset:3072
    s_waitcnt vmcnt(2)
    s_barrier
    ds_read_b128 v[20:23], v5 offset:20480
    ds_read_b128 v[24:27], v5 offset:20992
    ds_read_b128 v[28:31], v5 offset:21504
    ds_read_b128 v[32:35], v5 offset:22016
    v_mov_b32 v0, v10
    v_mov_b32 v56, 0
    v_mov_b32 v57, 0
    v_mov_b32 v58, 0
    v_mov_b32 v59, 0
    ds_read_b128 v[52:55], v7 offset:4096
    s_waitcnt lgkmcnt(0)
    v_mfma_f32_16x16x32_bf16 v[56:59], v[36:39], v[20:23], v[56:59]
    ds_read_b128 v[36:39], v7 offset:5120
    s_waitcnt lgkmcnt(4)
    v_mfma_f32_16x16x32_bf16 v[56:59], v[40:43], v[24:27], v[56:59]
    ds_read_b128 v[40:43], v7 offset:6144
    s_waitcnt lgkmcnt(4)
    v_mfma_f32_16x16x32_bf16 v[56:59], v[44:47], v[28:31], v[56:59]
    ds_read_b128 v[44:47], v7 offset:7168
    s_waitcnt lgkmcnt(4)
    v_mfma_f32_16x16x32_bf16 v[56:59], v[48:51], v[32:35], v[56:59]
    s_nop 7
    s_nop 1
    v_min_u32 v56, -2, v56
    v_min_u32 v57, -2, v57
    v_min_u32 v58, -2, v58
    v_min_u32 v59, -2, v59
    buffer_store_dwordx4 v[56:59], v0, s[8:11], s32 offen sc1
    v_add_u32 v0, 0x4000, v0
    v_mov_b32 v60, 0
    v_mov_b32 v61, 0
    v_mov_b32 v62, 0
    v_mov_b32 v63, 0
    ds_read_b128 v[48:51], v7 offset:8192
    s_waitcnt lgkmcnt(4)
    v_mfma_f32_16x16x32_bf16 v[60:63], v[52:55], v[20:23], v[60:63]
    ds_read_b128 v[52:55], v7 offset:9216
    s_waitcnt lgkmcnt(4)
    v_mfma_f32_16x16x32_bf16 v[60:63], v[36:39], v[24:27], v[60:63]
    ds_read_b128 v[36:39], v7 offset:10240
    s_waitcnt lgkmcnt(4)
    v_mfma_f32_16x16x32_bf16 v[60:63], v[40:43], v[28:31], v[60:63]
    ds_read_b128 v[40:43], v7 offset:11264
    s_waitcnt lgkmcnt(4)
    v_mfma_f32_16x16x32_bf16 v[60:63], v[44:47], v[32:35], v[60:63]
    s_nop 7
    s_nop 1
    v_min_u32 v60, -2, v60
    v_min_u32 v61, -2, v61
    v_min_u32 v62, -2, v62
    v_min_u32 v63, -2, v63
    buffer_store_dwordx4 v[60:63], v0, s[8:11], s32 offen sc1
    v_add_u32 v0, 0x4000, v0
    v_mov_b32 v56, 0
    v_mov_b32 v57, 0
    v_mov_b32 v58, 0
    v_mov_b32 v59, 0
    ds_read_b128 v[44:47], v7 offset:12288
    s_waitcnt lgkmcnt(4)
    v_mfma_f32_16x16x32_bf16 v[56:59], v[48:51], v[20:23], v[56:59]
    ds_read_b128 v[48:51], v7 offset:13312
    s_waitcnt lgkmcnt(4)
    v_mfma_f32_16x16x32_bf16 v[56:59], v[52:55], v[24:27], v[56:59]
    ds_read_b128 v[52:55], v7 offset:14336
    s_waitcnt lgkmcnt(4)
    v_mfma_f32_16x16x32_bf16 v[56:59], v[36:39], v[28:31], v[56:59]
    ds_read_b128 v[36:39], v7 offset:15360
    s_waitcnt lgkmcnt(4)
    v_mfma_f32_16x16x32_bf16 v[56:59], v[40:43], v[32:35], v[56:59]
    s_nop 7
    s_nop 1
    v_min_u32 v56, -2, v56
    v_min_u32 v57, -2, v57
    v_min_u32 v58, -2, v58
    v_min_u32 v59, -2, v59
    buffer_store_dwordx4 v[56:59], v0, s[8:11], s32 offen sc1
    v_add_u32 v0, 0x4000, v0
    v_mov_b32 v60, 0
    v_mov_b32 v61, 0
    v_mov_b32 v62, 0
    v_mov_b32 v63, 0
    s_waitcnt lgkmcnt(3)
    v_mfma_f32_16x16x32_bf16 v[60:63], v[44:47], v[20:23], v[60:63]
    s_waitcnt lgkmcnt(2)
    v_mfma_f32_16x16x32_bf16 v[60:63], v[48:51], v[24:27], v[60:63]
    s_waitcnt lgkmcnt(1)
    v_mfma_f32_16x16x32_bf16 v[60:63], v[52:55], v[28:31], v[60:63]
    s_waitcnt lgkmcnt(0)
    v_mfma_f32_16x16x32_bf16 v[60:63], v[36:39], v[32:35], v[60:63]
    s_nop 7
    s_nop 1
    v_min_u32 v60, -2, v60
    v_min_u32 v61, -2, v61
    v_min_u32 v62, -2, v62
    v_min_u32 v63, -2, v63
    buffer_store_dwordx4 v[60:63], v0, s[8:11], s32 offen sc1
    v_add_u32 v0, 0x4000, v0
    s_cmp_ge_u32 s20, 4
    s_cbranch_scc1 .g558
    s_add_u32 s34, s34, 0x80000
    s_add_u32 s35, s35, 64
    s_add_u32 s21, s30, 1
    s_and_b32 s22, s21, 3
    s_cmp_lg_u32 s22, 0
    s_cbranch_scc1 .nk60
    s_lshl_b32 s21, s21, 5
    s_lshl_b32 s22, s2, 2
    s_add_u32 s21, s21, s22
    s_add_u32 s21, s21, 0x7100000
    v_mov_b32 v36, s21
    s_mov_b32 s37, 0
.wf61:
    buffer_load_dword v37, v36, s[8:11], 0 offen sc1
    s_waitcnt vmcnt(0)
    v_readfirstlane_b32 s38, v37
    s_add_u32 s37, s37, 1
    s_cmp_lg_u32 s38, 0
    s_cbranch_scc1 .wfd62
    s_sleep 2
    s_cmp_lt_u32 s37, 1048576
    s_cbranch_scc1 .wf61
.wfd62:
.nk60:
    s_lshl_b32 s21, s20, 11
    s_add_u32 s21, s21, 8192
    s_mov_b32 m0, s21
    s_nop 0
    buffer_load_dwordx4 v15, s[8:11], s34 offen sc1 lds
    s_add_u32 s21, s21, 1024
    s_mov_b32 m0, s21
    v_add_u32 v0, 64, v15
    buffer_load_dwordx4 v0, s[8:11], s34 offen sc1 lds
    s_lshl_b32 s21, s20, 10
    s_add_u32 s21, s21, 24576
    s_mov_b32 m0, s21
    s_nop 0
    buffer_load_dwordx4 v16, s[8:11], s35 offen sc1 lds
    s_add_u32 s21, s21, 4096
    s_mov_b32 m0, s21
    v_add_u32 v0, 0x40000, v16
    buffer_load_dwordx4 v0, s[8:11], s35 offen sc1 lds
    s_branch .b459
.g558:
    s_add_u32 s60, s32, 0
    s_add_u32 s61, s32, 4096
    s_add_u32 s62, s32, 8192
    s_add_u32 s63, s32, 12288
    s_mov_b32 s36, 0
    buffer_load_dwordx4 v[20:23], v11, s[8:11], s60 offen sc1
    buffer_load_dwordx4 v[24:27], v11, s[8:11], s61 offen sc1
    buffer_load_dwordx4 v[28:31], v11, s[8:11], s62 offen sc1
    buffer_load_dwordx4 v[32:35], v11, s[8:11], s63 offen sc1
.p163:
    buffer_load_dwordx4 v[36:39], v11, s[8:11], s60 offen sc1
    buffer_load_dwordx4 v[40:43], v11, s[8:11], s61 offen sc1
    buffer_load_dwordx4 v[44:47], v11, s[8:11], s62 offen sc1
    buffer_load_dwordx4 v[48:51], v11, s[8:11], s63 offen sc1
    s_waitcnt vmcnt(4)
    v_max_u32 v52, v20, v21
    v_max3_u32 v52, v52, v22, v23
    v_max3_u32 v52, v52, v24, v25
    v_max3_u32 v52, v52, v26, v27
    v_max3_u32 v52, v52, v28, v29
    v_max3_u32 v52, v52, v30, v31
    v_max3_u32 v52, v52, v32, v33
    v_max3_u32 v52, v52, v34, v35
    v_cmp_ne_u32 vcc, -1, v52
    s_cmp_eq_u64 vcc, exec
    s_cbranch_scc1 .p1a64
    buffer_load_dwordx4 v[20:23], v11, s[8:11], s60 offen sc1
    buffer_load_dwordx4 v[24:27], v11, s[8:11], s61 offen sc1
    buffer_load_dwordx4 v[28:31], v11, s[8:11], s62 offen sc1
    buffer_load_dwordx4 v[32:35], v11, s[8:11], s63 offen sc1
    s_waitcnt vmcnt(4)
    v_max_u32 v52, v36, v37
    v_max3_u32 v52, v52, v38, v39
    v_max3_u32 v52, v52, v40, v41
    v_max3_u32 v52, v52, v42, v43
    v_max3_u32 v52, v52, v44, v45
    v_max3_u32 v52, v52, v46, v47
    v_max3_u32 v52, v52, v48, v49
    v_max3_u32 v52, v52, v50, v51
    v_cmp_ne_u32 vcc, -1, v52
    s_cmp_eq_u64 vcc, exec
    s_cbranch_scc1 .p1b65
    s_add_u32 s36, s36, 1
    s_cmp_lt_u32 s36, 131072
    s_cbranch_scc1 .p163
    s_branch .p1a64
.p1b65:
    v_add_f32 v52, v36, v40
    v_add_f32 v56, v44, v48
    v_add_f32 v53, v37, v41
    v_add_f32 v57, v45, v49
    v_add_f32 v54, v38, v42
    v_add_f32 v58, v46, v50
    v_add_f32 v55, v39, v43
    v_add_f32 v59, v47, v51
    v_add_f32 v52, v52, v56
    v_add_f32 v53, v53, v57
    v_add_f32 v54, v54, v58
    v_add_f32 v55, v55, v59
    s_branch .p1j66
.p1a64:
    v_add_f32 v52, v20, v24
    v_add_f32 v56, v28, v32
    v_add_f32 v53, v21, v25
    v_add_f32 v57, v29, v33
    v_add_f32 v54, v22, v26
    v_add_f32 v58, v30, v34
    v_add_f32 v55, v23, v27
    v_add_f32 v59, v31, v35
    v_add_f32 v52, v52, v56
    v_add_f32 v53, v53, v57
    v_add_f32 v54, v54, v58
    v_add_f32 v55, v55, v59
.p1j66:
    s_nop 1
    v_add_f32_dpp v56, v52, v52 row_ror:8 row_mask:0xf bank_mask:0xf
    v_add_f32_dpp v57, v53, v53 row_ror:8 row_mask:0xf bank_mask:0xf
    v_add_f32_dpp v58, v54, v54 row_ror:8 row_mask:0xf bank_mask:0xf
    v_add_f32_dpp v59, v55, v55 row_ror:8 row_mask:0xf bank_mask:0xf
    v_mov_b32 v52, v56
    v_mov_b32 v53, v57
    v_mov_b32 v54, v58
    v_mov_b32 v55, v59
    s_nop 1
    v_permlane16_swap_b32 v52, v56
    v_permlane16_swap_b32 v53, v57
    v_permlane16_swap_b32 v54, v58
    v_permlane16_swap_b32 v55, v59
    s_nop 1
    v_add_f32 v52, v52, v56
    v_add_f32 v53, v53, v57
    v_add_f32 v54, v54, v58
    v_add_f32 v55, v55, v59
    v_mov_b32 v56, v52
    v_mov_b32 v57, v53
    v_mov_b32 v58, v54
    v_mov_b32 v59, v55
    s_nop 1
    v_permlane32_swap_b32 v52, v56
    v_permlane32_swap_b32 v53, v57
    v_permlane32_swap_b32 v54, v58
    v_permlane32_swap_b32 v55, v59
    s_nop 1
    v_add_f32 v52, v52, v56
    v_add_f32 v53, v53, v57
    v_add_f32 v54, v54, v58
    v_add_f32 v55, v55, v59
    v_cvt_pk_bf16_f32 v56, v52, v53
    v_cvt_pk_bf16_f32 v57, v54, v55
    v_min_u32 v56, -2, v56
    v_min_u32 v57, -2, v57
    buffer_store_dwordx2 v[56:57], v17, s[8:11], s31 offen sc1
.b459:
    s_add_u32 s30, s30, 1
    s_add_u32 s31, s31, 8192
    s_add_u32 s32, s32, 0x80000
    s_add_u32 s33, s33, 0x10000
    s_branch .step45

.last53:
    v_mov_b32 v44, 0
    v_mov_b32 v45, 0
    v_mov_b32 v46, 0
    v_mov_b32 v47, 0
    ds_read_b128 v[20:23], v4
    ds_read_b128 v[24:27], v4 offset:512
    ds_read_b128 v[28:31], v4 offset:1024
    ds_read_b128 v[32:35], v4 offset:1536
    s_waitcnt lgkmcnt(3)
    v_mfma_f32_16x16x32_bf16 v[44:47], v[20:23], v[192:195], v[44:47]
    ds_read_b128 v[20:23], v4 offset:2048
    s_waitcnt lgkmcnt(3)
    v_mfma_f32_16x16x32_bf16 v[44:47], v[24:27], v[196:199], v[44:47]
    ds_read_b128 v[24:27], v4 offset:2560
    s_waitcnt lgkmcnt(3)
    v_mfma_f32_16x16x32_bf16 v[44:47], v[28:31], v[200:203], v[44:47]
    ds_read_b128 v[28:31], v4 offset:3072
    s_waitcnt lgkmcnt(3)
    v_mfma_f32_16x16x32_bf16 v[44:47], v[32:35], v[204:207], v[44:47]
    ds_read_b128 v[32:35], v4 offset:3584
    s_waitcnt lgkmcnt(3)
    v_mfma_f32_16x16x32_bf16 v[44:47], v[20:23], v[208:211], v[44:47]
    ds_read_b128 v[20:23], v4 offset:4096
    s_waitcnt lgkmcnt(3)
    v_mfma_f32_16x16x32_bf16 v[44:47], v[24:27], v[212:215], v[44:47]
    ds_read_b128 v[24:27], v4 offset:4608
    s_waitcnt lgkmcnt(3)
    v_mfma_f32_16x16x32_bf16 v[44:47], v[28:31], v[216:219], v[44:47]
    ds_read_b128 v[28:31], v4 offset:5120
    s_waitcnt lgkmcnt(3)
    v_mfma_f32_16x16x32_bf16 v[44:47], v[32:35], v[220:223], v[44:47]
    ds_read_b128 v[32:35], v4 offset:5632
    s_waitcnt lgkmcnt(3)
    v_mfma_f32_16x16x32_bf16 v[44:47], v[20:23], v[224:227], v[44:47]
    ds_read_b128 v[20:23], v4 offset:6144
    s_waitcnt lgkmcnt(3)
    v_mfma_f32_16x16x32_bf16 v[44:47], v[24:27], v[228:231], v[44:47]
    ds_read_b128 v[24:27], v4 offset:6656
    s_waitcnt lgkmcnt(3)
    v_mfma_f32_16x16x32_bf16 v[44:47], v[28:31], v[232:235], v[44:47]
    ds_read_b128 v[28:31], v4 offset:7168
    s_waitcnt lgkmcnt(3)
    v_mfma_f32_16x16x32_bf16 v[44:47], v[32:35], v[236:239], v[44:47]
    ds_read_b128 v[32:35], v4 offset:7680
    s_waitcnt lgkmcnt(3)
    v_mfma_f32_16x16x32_bf16 v[44:47], v[20:23], v[240:243], v[44:47]
    s_waitcnt lgkmcnt(2)
    v_mfma_f32_16x16x32_bf16 v[44:47], v[24:27], v[244:247], v[44:47]
    s_waitcnt lgkmcnt(1)
    v_mfma_f32_16x16x32_bf16 v[44:47], v[28:31], v[248:251], v[44:47]
    s_waitcnt lgkmcnt(0)
    v_mfma_f32_16x16x32_bf16 v[44:47], v[32:35], v[252:255], v[44:47]
    s_nop 7
    s_nop 1
    v_cvt_pk_bf16_f32 v18, v44, v45
    v_cvt_pk_bf16_f32 v19, v46, v47
    buffer_store_dwordx2 v[18:19], v14, s[8:11], s33 offen sc1
    s_waitcnt vmcnt(0)
    s_barrier
    s_cmp_lg_u32 s20, 5
    s_cbranch_scc1 .mend12
    s_lshl_b32 s22, s2, 2
    s_add_u32 s21, s22, 0x7103f80
    v_mov_b32 v36, s21
    v_mov_b32 v37, 1
    s_mov_b64 exec, 1
    buffer_store_dword v37, v36, s[8:11], 0 offen sc1
    v_subrev_u32 v36, 128, v36
    buffer_store_dword v37, v36, s[8:11], 0 offen sc1
    s_branch .mend12
.mwk13:
    s_mul_i32 s29, s21, 7
    s_add_u32 s29, s29, s3
    s_sub_u32 s29, s29, 1
    v_and_b32 v2, 15, v1
    v_lshrrev_b32 v3, 4, v1
    s_and_b32 s24, s20, 3
    s_lshr_b32 s42, s20, 2
    s_mov_b32 s43, s29

.gt67:
    s_cmp_ge_u32 s43, 768
    s_cbranch_scc1 .gdone70
    s_cmp_ge_u32 s43, 512
    s_cbranch_scc1 .gq68
    s_lshr_b32 s44, s43, 5
    s_and_b32 s45, s43, 31
    s_lshl_b32 s46, s45, 3
    s_lshl_b32 s47, s42, 8
    s_add_u32 s46, s46, s47
    s_add_u32 s46, s46, 256
    s_lshl_b32 s47, s44, 7
    s_lshl_b32 s48, s43, 2
    s_add_u32 s48, s48, 0x7100000
    s_branch .ggo69

.gq68:
    s_sub_u32 s45, s43, 512
    s_lshr_b32 s44, s45, 4
    s_and_b32 s45, s45, 15
    s_lshl_b32 s45, s45, 1
    s_add_u32 s45, s45, s42
    s_lshl_b32 s46, s45, 3
    s_lshl_b32 s47, s44, 7
    s_lshl_b32 s48, s44, 5
    s_add_u32 s48, s48, s45
    s_lshl_b32 s48, s48, 2
    s_add_u32 s48, s48, 0x7101000

.ggo69:
    s_barrier
    s_lshl_b32 s21, s20, 4
    s_add_u32 s22, s21, s47
    s_lshl_b32 s22, s22, 10
    s_add_u32 s22, s22, 0x0
    v_lshl_add_u32 v4, v1, 4, s22
    s_mul_i32 s21, s21, 1040
    v_lshl_add_u32 v5, v1, 4, s21

    buffer_load_dwordx4 v[16:19], v4, s[8:11], 0 offen offset:0
    buffer_load_dwordx4 v[20:23], v4, s[8:11], 0 offen offset:1024
    buffer_load_dwordx4 v[24:27], v4, s[8:11], 0 offen offset:2048
    buffer_load_dwordx4 v[28:31], v4, s[8:11], 0 offen offset:3072
    v_add_u32 v4, 0x1000, v4
    buffer_load_dwordx4 v[32:35], v4, s[8:11], 0 offen offset:0
    buffer_load_dwordx4 v[36:39], v4, s[8:11], 0 offen offset:1024
    buffer_load_dwordx4 v[40:43], v4, s[8:11], 0 offen offset:2048
    buffer_load_dwordx4 v[44:47], v4, s[8:11], 0 offen offset:3072
    s_waitcnt vmcnt(7)
    ds_write_b128 v5, v[16:19] offset:0
    s_waitcnt vmcnt(6)
    ds_write_b128 v5, v[20:23] offset:1040
    s_waitcnt vmcnt(5)
    ds_write_b128 v5, v[24:27] offset:2080
    s_waitcnt vmcnt(4)
    ds_write_b128 v5, v[28:31] offset:3120
    s_waitcnt vmcnt(3)
    ds_write_b128 v5, v[32:35] offset:4160
    s_waitcnt vmcnt(2)
    ds_write_b128 v5, v[36:39] offset:5200
    s_waitcnt vmcnt(1)
    ds_write_b128 v5, v[40:43] offset:6240
    s_waitcnt vmcnt(0)
    ds_write_b128 v5, v[44:47] offset:7280
    v_add_u32 v4, 0x1000, v4
    buffer_load_dwordx4 v[16:19], v4, s[8:11], 0 offen offset:0
    buffer_load_dwordx4 v[20:23], v4, s[8:11], 0 offen offset:1024
    buffer_load_dwordx4 v[24:27], v4, s[8:11], 0 offen offset:2048
    buffer_load_dwordx4 v[28:31], v4, s[8:11], 0 offen offset:3072
    v_add_u32 v4, 0x1000, v4
    buffer_load_dwordx4 v[32:35], v4, s[8:11], 0 offen offset:0
    buffer_load_dwordx4 v[36:39], v4, s[8:11], 0 offen offset:1024
    buffer_load_dwordx4 v[40:43], v4, s[8:11], 0 offen offset:2048
    buffer_load_dwordx4 v[44:47], v4, s[8:11], 0 offen offset:3072
    s_waitcnt vmcnt(7)
    ds_write_b128 v5, v[16:19] offset:8320
    s_waitcnt vmcnt(6)
    ds_write_b128 v5, v[20:23] offset:9360
    s_waitcnt vmcnt(5)
    ds_write_b128 v5, v[24:27] offset:10400
    s_waitcnt vmcnt(4)
    ds_write_b128 v5, v[28:31] offset:11440
    s_waitcnt vmcnt(3)
    ds_write_b128 v5, v[32:35] offset:12480
    s_waitcnt vmcnt(2)
    ds_write_b128 v5, v[36:39] offset:13520
    s_waitcnt vmcnt(1)
    ds_write_b128 v5, v[40:43] offset:14560
    s_waitcnt vmcnt(0)
    ds_write_b128 v5, v[44:47] offset:15600
    s_waitcnt lgkmcnt(0)
    s_barrier
    s_lshl_b32 s25, s24, 1
    s_add_u32 s22, s46, s25
    s_mov_b32 s23, 1040
    v_mul_lo_u32 v4, v2, s23
    v_lshl_add_u32 v4, v3, 4, v4

    v_add_u32 v200, 0, v4
    v_add_u32 v201, 16640, v4
    v_add_u32 v202, 33280, v4
    v_add_u32 v203, 49920, v4
    v_add_u32 v204, 66560, v4
    v_add_u32 v205, 83200, v4
    v_add_u32 v206, 99840, v4
    v_add_u32 v207, 116480, v4
    s_lshl_b32 s25, s22, 14
    s_add_u32 s25, s25, 0x200000
    v_lshl_add_u32 v4, v1, 4, s25
    v_add_u32 v12, 0, v4
    v_add_u32 v13, 16384, v4
    s_mov_b32 s26, 0
    s_mov_b32 s27, 0
    s_cmp_ge_u32 s22, 512
    s_cbranch_scc1 .wv71
    v_mov_b32 v96, 0
    v_mov_b32 v97, 0
    v_mov_b32 v98, 0
    v_mov_b32 v99, 0
    v_mov_b32 v100, 0
    v_mov_b32 v101, 0
    v_mov_b32 v102, 0
    v_mov_b32 v103, 0
    v_mov_b32 v104, 0
    v_mov_b32 v105, 0
    v_mov_b32 v106, 0
    v_mov_b32 v107, 0
    v_mov_b32 v108, 0
    v_mov_b32 v109, 0
    v_mov_b32 v110, 0
    v_mov_b32 v111, 0
    v_mov_b32 v112, 0
    v_mov_b32 v113, 0
    v_mov_b32 v114, 0
    v_mov_b32 v115, 0
    v_mov_b32 v116, 0
    v_mov_b32 v117, 0
    v_mov_b32 v118, 0
    v_mov_b32 v119, 0
    v_mov_b32 v120, 0
    v_mov_b32 v121, 0
    v_mov_b32 v122, 0
    v_mov_b32 v123, 0
    v_mov_b32 v124, 0
    v_mov_b32 v125, 0
    v_mov_b32 v126, 0
    v_mov_b32 v127, 0
    v_mov_b32 v128, 0
    v_mov_b32 v129, 0
    v_mov_b32 v130, 0
    v_mov_b32 v131, 0
    v_mov_b32 v132, 0
    v_mov_b32 v133, 0
    v_mov_b32 v134, 0
    v_mov_b32 v135, 0
    v_mov_b32 v136, 0
    v_mov_b32 v137, 0
    v_mov_b32 v138, 0
    v_mov_b32 v139, 0
    v_mov_b32 v140, 0
    v_mov_b32 v141, 0
    v_mov_b32 v142, 0
    v_mov_b32 v143, 0
    v_mov_b32 v144, 0
    v_mov_b32 v145, 0
    v_mov_b32 v146, 0
    v_mov_b32 v147, 0
    v_mov_b32 v148, 0
    v_mov_b32 v149, 0
    v_mov_b32 v150, 0
    v_mov_b32 v151, 0
    v_mov_b32 v152, 0
    v_mov_b32 v153, 0
    v_mov_b32 v154, 0
    v_mov_b32 v155, 0
    v_mov_b32 v156, 0
    v_mov_b32 v157, 0
    v_mov_b32 v158, 0
    v_mov_b32 v159, 0
    buffer_load_dwordx4 v[80:83], v12, s[8:11], s27 offen
    buffer_load_dwordx4 v[84:87], v13, s[8:11], s27 offen
    ds_read_b128 v[16:19], v200
    v_add_u32 v200, 64, v200
    ds_read_b128 v[20:23], v201
    v_add_u32 v201, 64, v201
    ds_read_b128 v[24:27], v202
    v_add_u32 v202, 64, v202
    ds_read_b128 v[28:31], v203
    v_add_u32 v203, 64, v203
    ds_read_b128 v[32:35], v204
    v_add_u32 v204, 64, v204
    ds_read_b128 v[36:39], v205
    v_add_u32 v205, 64, v205
    ds_read_b128 v[40:43], v206
    v_add_u32 v206, 64, v206
    ds_read_b128 v[44:47], v207
    v_add_u32 v207, 64, v207
    s_add_u32 s26, s26, 64
    s_add_u32 s27, s27, 1024
    s_mov_b32 s28, 8
.gl73:
    buffer_load_dwordx4 v[88:91], v12, s[8:11], s27 offen
    buffer_load_dwordx4 v[92:95], v13, s[8:11], s27 offen
    ds_read_b128 v[48:51], v200
    v_add_u32 v200, 64, v200
    ds_read_b128 v[52:55], v201
    v_add_u32 v201, 64, v201
    ds_read_b128 v[56:59], v202
    v_add_u32 v202, 64, v202
    ds_read_b128 v[60:63], v203
    v_add_u32 v203, 64, v203
    ds_read_b128 v[64:67], v204
    v_add_u32 v204, 64, v204
    ds_read_b128 v[68:71], v205
    v_add_u32 v205, 64, v205
    ds_read_b128 v[72:75], v206
    v_add_u32 v206, 64, v206
    ds_read_b128 v[76:79], v207
    v_add_u32 v207, 64, v207
    s_add_u32 s26, s26, 64
    s_add_u32 s27, s27, 1024
    s_waitcnt vmcnt(2) lgkmcnt(8)
    v_mfma_f32_16x16x32_bf16 v[96:99], v[80:83], v[16:19], v[96:99]
    v_mfma_f32_16x16x32_bf16 v[100:103], v[80:83], v[20:23], v[100:103]
    v_mfma_f32_16x16x32_bf16 v[104:107], v[80:83], v[24:27], v[104:107]
    v_mfma_f32_16x16x32_bf16 v[108:111], v[80:83], v[28:31], v[108:111]
    v_mfma_f32_16x16x32_bf16 v[112:115], v[80:83], v[32:35], v[112:115]
    v_mfma_f32_16x16x32_bf16 v[116:119], v[80:83], v[36:39], v[116:119]
    v_mfma_f32_16x16x32_bf16 v[120:123], v[80:83], v[40:43], v[120:123]
    v_mfma_f32_16x16x32_bf16 v[124:127], v[80:83], v[44:47], v[124:127]
    v_mfma_f32_16x16x32_bf16 v[128:131], v[84:87], v[16:19], v[128:131]
    v_mfma_f32_16x16x32_bf16 v[132:135], v[84:87], v[20:23], v[132:135]
    v_mfma_f32_16x16x32_bf16 v[136:139], v[84:87], v[24:27], v[136:139]
    v_mfma_f32_16x16x32_bf16 v[140:143], v[84:87], v[28:31], v[140:143]
    v_mfma_f32_16x16x32_bf16 v[144:147], v[84:87], v[32:35], v[144:147]
    v_mfma_f32_16x16x32_bf16 v[148:151], v[84:87], v[36:39], v[148:151]
    v_mfma_f32_16x16x32_bf16 v[152:155], v[84:87], v[40:43], v[152:155]
    v_mfma_f32_16x16x32_bf16 v[156:159], v[84:87], v[44:47], v[156:159]
    buffer_load_dwordx4 v[80:83], v12, s[8:11], s27 offen
    buffer_load_dwordx4 v[84:87], v13, s[8:11], s27 offen
    ds_read_b128 v[16:19], v200
    v_add_u32 v200, 64, v200
    ds_read_b128 v[20:23], v201
    v_add_u32 v201, 64, v201
    ds_read_b128 v[24:27], v202
    v_add_u32 v202, 64, v202
    ds_read_b128 v[28:31], v203
    v_add_u32 v203, 64, v203
    ds_read_b128 v[32:35], v204
    v_add_u32 v204, 64, v204
    ds_read_b128 v[36:39], v205
    v_add_u32 v205, 64, v205
    ds_read_b128 v[40:43], v206
    v_add_u32 v206, 64, v206
    ds_read_b128 v[44:47], v207
    v_add_u32 v207, 64, v207
    s_add_u32 s26, s26, 64
    s_add_u32 s27, s27, 1024
    s_waitcnt vmcnt(2) lgkmcnt(8)
    v_mfma_f32_16x16x32_bf16 v[96:99], v[88:91], v[48:51], v[96:99]
    v_mfma_f32_16x16x32_bf16 v[100:103], v[88:91], v[52:55], v[100:103]
    v_mfma_f32_16x16x32_bf16 v[104:107], v[88:91], v[56:59], v[104:107]
    v_mfma_f32_16x16x32_bf16 v[108:111], v[88:91], v[60:63], v[108:111]
    v_mfma_f32_16x16x32_bf16 v[112:115], v[88:91], v[64:67], v[112:115]
    v_mfma_f32_16x16x32_bf16 v[116:119], v[88:91], v[68:71], v[116:119]
    v_mfma_f32_16x16x32_bf16 v[120:123], v[88:91], v[72:75], v[120:123]
    v_mfma_f32_16x16x32_bf16 v[124:127], v[88:91], v[76:79], v[124:127]
    v_mfma_f32_16x16x32_bf16 v[128:131], v[92:95], v[48:51], v[128:131]
    v_mfma_f32_16x16x32_bf16 v[132:135], v[92:95], v[52:55], v[132:135]
    v_mfma_f32_16x16x32_bf16 v[136:139], v[92:95], v[56:59], v[136:139]
    v_mfma_f32_16x16x32_bf16 v[140:143], v[92:95], v[60:63], v[140:143]
    v_mfma_f32_16x16x32_bf16 v[144:147], v[92:95], v[64:67], v[144:147]
    v_mfma_f32_16x16x32_bf16 v[148:151], v[92:95], v[68:71], v[148:151]
    v_mfma_f32_16x16x32_bf16 v[152:155], v[92:95], v[72:75], v[152:155]
    v_mfma_f32_16x16x32_bf16 v[156:159], v[92:95], v[76:79], v[156:159]
    s_sub_u32 s28, s28, 1
    s_cmp_lg_u32 s28, 0
    s_cbranch_scc1 .gl73
    s_waitcnt vmcnt(0) lgkmcnt(0)
    s_nop 7
    s_nop 7
    v_add_u32 v4, s47, v2
    v_lshlrev_b32 v4, 14, v4
    s_lshl_b32 s25, s22, 5
    v_lshl_add_u32 v4, v3, 3, v4
    v_add_u32 v4, s25, v4
    v_add_u32 v4, 0x1800000, v4

    v_cvt_pk_bf16_f32 v16, v96, v97
    v_cvt_pk_bf16_f32 v17, v98, v99
    buffer_store_dwordx2 v[16:17], v4, s[8:11], 0 offen offset:0 sc1
    s_nop 1
    v_cvt_pk_bf16_f32 v18, v128, v129
    v_cvt_pk_bf16_f32 v19, v130, v131
    buffer_store_dwordx2 v[18:19], v4, s[8:11], 0 offen offset:32 sc1
    s_nop 1
    v_add_u32 v4, 0x40000, v4
    v_cvt_pk_bf16_f32 v16, v100, v101
    v_cvt_pk_bf16_f32 v17, v102, v103
    buffer_store_dwordx2 v[16:17], v4, s[8:11], 0 offen offset:0 sc1
    s_nop 1
    v_cvt_pk_bf16_f32 v18, v132, v133
    v_cvt_pk_bf16_f32 v19, v134, v135
    buffer_store_dwordx2 v[18:19], v4, s[8:11], 0 offen offset:32 sc1
    s_nop 1
    v_add_u32 v4, 0x40000, v4
    v_cvt_pk_bf16_f32 v16, v104, v105
    v_cvt_pk_bf16_f32 v17, v106, v107
    buffer_store_dwordx2 v[16:17], v4, s[8:11], 0 offen offset:0 sc1
    s_nop 1
    v_cvt_pk_bf16_f32 v18, v136, v137
    v_cvt_pk_bf16_f32 v19, v138, v139
    buffer_store_dwordx2 v[18:19], v4, s[8:11], 0 offen offset:32 sc1
    s_nop 1
    v_add_u32 v4, 0x40000, v4
    v_cvt_pk_bf16_f32 v16, v108, v109
    v_cvt_pk_bf16_f32 v17, v110, v111
    buffer_store_dwordx2 v[16:17], v4, s[8:11], 0 offen offset:0 sc1
    s_nop 1
    v_cvt_pk_bf16_f32 v18, v140, v141
    v_cvt_pk_bf16_f32 v19, v142, v143
    buffer_store_dwordx2 v[18:19], v4, s[8:11], 0 offen offset:32 sc1
    s_nop 1
    v_add_u32 v4, 0x40000, v4
    v_cvt_pk_bf16_f32 v16, v112, v113
    v_cvt_pk_bf16_f32 v17, v114, v115
    buffer_store_dwordx2 v[16:17], v4, s[8:11], 0 offen offset:0 sc1
    s_nop 1
    v_cvt_pk_bf16_f32 v18, v144, v145
    v_cvt_pk_bf16_f32 v19, v146, v147
    buffer_store_dwordx2 v[18:19], v4, s[8:11], 0 offen offset:32 sc1
    s_nop 1
    v_add_u32 v4, 0x40000, v4
    v_cvt_pk_bf16_f32 v16, v116, v117
    v_cvt_pk_bf16_f32 v17, v118, v119
    buffer_store_dwordx2 v[16:17], v4, s[8:11], 0 offen offset:0 sc1
    s_nop 1
    v_cvt_pk_bf16_f32 v18, v148, v149
    v_cvt_pk_bf16_f32 v19, v150, v151
    buffer_store_dwordx2 v[18:19], v4, s[8:11], 0 offen offset:32 sc1
    s_nop 1
    v_add_u32 v4, 0x40000, v4
    v_cvt_pk_bf16_f32 v16, v120, v121
    v_cvt_pk_bf16_f32 v17, v122, v123
    buffer_store_dwordx2 v[16:17], v4, s[8:11], 0 offen offset:0 sc1
    s_nop 1
    v_cvt_pk_bf16_f32 v18, v152, v153
    v_cvt_pk_bf16_f32 v19, v154, v155
    buffer_store_dwordx2 v[18:19], v4, s[8:11], 0 offen offset:32 sc1
    s_nop 1
    v_add_u32 v4, 0x40000, v4
    v_cvt_pk_bf16_f32 v16, v124, v125
    v_cvt_pk_bf16_f32 v17, v126, v127
    buffer_store_dwordx2 v[16:17], v4, s[8:11], 0 offen offset:0 sc1
    s_nop 1
    v_cvt_pk_bf16_f32 v18, v156, v157
    v_cvt_pk_bf16_f32 v19, v158, v159
    buffer_store_dwordx2 v[18:19], v4, s[8:11], 0 offen offset:32 sc1
    s_nop 1
    s_branch .wdn72
.wv71:
    v_mov_b32 v96, 0
    v_mov_b32 v97, 0
    v_mov_b32 v98, 0
    v_mov_b32 v99, 0
    v_mov_b32 v100, 0
    v_mov_b32 v101, 0
    v_mov_b32 v102, 0
    v_mov_b32 v103, 0
    v_mov_b32 v104, 0
    v_mov_b32 v105, 0
    v_mov_b32 v106, 0
    v_mov_b32 v107, 0
    v_mov_b32 v108, 0
    v_mov_b32 v109, 0
    v_mov_b32 v110, 0
    v_mov_b32 v111, 0
    v_mov_b32 v112, 0
    v_mov_b32 v113, 0
    v_mov_b32 v114, 0
    v_mov_b32 v115, 0
    v_mov_b32 v116, 0
    v_mov_b32 v117, 0
    v_mov_b32 v118, 0
    v_mov_b32 v119, 0
    v_mov_b32 v120, 0
    v_mov_b32 v121, 0
    v_mov_b32 v122, 0
    v_mov_b32 v123, 0
    v_mov_b32 v124, 0
    v_mov_b32 v125, 0
    v_mov_b32 v126, 0
    v_mov_b32 v127, 0
    v_mov_b32 v128, 0
    v_mov_b32 v129, 0
    v_mov_b32 v130, 0
    v_mov_b32 v131, 0
    v_mov_b32 v132, 0
    v_mov_b32 v133, 0
    v_mov_b32 v134, 0
    v_mov_b32 v135, 0
    v_mov_b32 v136, 0
    v_mov_b32 v137, 0
    v_mov_b32 v138, 0
    v_mov_b32 v139, 0
    v_mov_b32 v140, 0
    v_mov_b32 v141, 0
    v_mov_b32 v142, 0
    v_mov_b32 v143, 0
    v_mov_b32 v144, 0
    v_mov_b32 v145, 0
    v_mov_b32 v146, 0
    v_mov_b32 v147, 0
    v_mov_b32 v148, 0
    v_mov_b32 v149, 0
    v_mov_b32 v150, 0
    v_mov_b32 v151, 0
    v_mov_b32 v152, 0
    v_mov_b32 v153, 0
    v_mov_b32 v154, 0
    v_mov_b32 v155, 0
    v_mov_b32 v156, 0
    v_mov_b32 v157, 0
    v_mov_b32 v158, 0
    v_mov_b32 v159, 0
    buffer_load_dwordx4 v[80:83], v12, s[8:11], s27 offen
    buffer_load_dwordx4 v[84:87], v13, s[8:11], s27 offen
    ds_read_b128 v[16:19], v200
    v_add_u32 v200, 64, v200
    ds_read_b128 v[20:23], v201
    v_add_u32 v201, 64, v201
    ds_read_b128 v[24:27], v202
    v_add_u32 v202, 64, v202
    ds_read_b128 v[28:31], v203
    v_add_u32 v203, 64, v203
    ds_read_b128 v[32:35], v204
    v_add_u32 v204, 64, v204
    ds_read_b128 v[36:39], v205
    v_add_u32 v205, 64, v205
    ds_read_b128 v[40:43], v206
    v_add_u32 v206, 64, v206
    ds_read_b128 v[44:47], v207
    v_add_u32 v207, 64, v207
    s_add_u32 s26, s26, 64
    s_add_u32 s27, s27, 1024
    s_mov_b32 s28, 8
.gl74:
    buffer_load_dwordx4 v[88:91], v12, s[8:11], s27 offen
    buffer_load_dwordx4 v[92:95], v13, s[8:11], s27 offen
    ds_read_b128 v[48:51], v200
    v_add_u32 v200, 64, v200
    ds_read_b128 v[52:55], v201
    v_add_u32 v201, 64, v201
    ds_read_b128 v[56:59], v202
    v_add_u32 v202, 64, v202
    ds_read_b128 v[60:63], v203
    v_add_u32 v203, 64, v203
    ds_read_b128 v[64:67], v204
    v_add_u32 v204, 64, v204
    ds_read_b128 v[68:71], v205
    v_add_u32 v205, 64, v205
    ds_read_b128 v[72:75], v206
    v_add_u32 v206, 64, v206
    ds_read_b128 v[76:79], v207
    v_add_u32 v207, 64, v207
    s_add_u32 s26, s26, 64
    s_add_u32 s27, s27, 1024
    s_waitcnt vmcnt(2) lgkmcnt(8)
    v_mfma_f32_16x16x32_bf16 v[96:99], v[16:19], v[80:83], v[96:99]
    v_mfma_f32_16x16x32_bf16 v[100:103], v[20:23], v[80:83], v[100:103]
    v_mfma_f32_16x16x32_bf16 v[104:107], v[24:27], v[80:83], v[104:107]
    v_mfma_f32_16x16x32_bf16 v[108:111], v[28:31], v[80:83], v[108:111]
    v_mfma_f32_16x16x32_bf16 v[112:115], v[32:35], v[80:83], v[112:115]
    v_mfma_f32_16x16x32_bf16 v[116:119], v[36:39], v[80:83], v[116:119]
    v_mfma_f32_16x16x32_bf16 v[120:123], v[40:43], v[80:83], v[120:123]
    v_mfma_f32_16x16x32_bf16 v[124:127], v[44:47], v[80:83], v[124:127]
    v_mfma_f32_16x16x32_bf16 v[128:131], v[16:19], v[84:87], v[128:131]
    v_mfma_f32_16x16x32_bf16 v[132:135], v[20:23], v[84:87], v[132:135]
    v_mfma_f32_16x16x32_bf16 v[136:139], v[24:27], v[84:87], v[136:139]
    v_mfma_f32_16x16x32_bf16 v[140:143], v[28:31], v[84:87], v[140:143]
    v_mfma_f32_16x16x32_bf16 v[144:147], v[32:35], v[84:87], v[144:147]
    v_mfma_f32_16x16x32_bf16 v[148:151], v[36:39], v[84:87], v[148:151]
    v_mfma_f32_16x16x32_bf16 v[152:155], v[40:43], v[84:87], v[152:155]
    v_mfma_f32_16x16x32_bf16 v[156:159], v[44:47], v[84:87], v[156:159]
    buffer_load_dwordx4 v[80:83], v12, s[8:11], s27 offen
    buffer_load_dwordx4 v[84:87], v13, s[8:11], s27 offen
    ds_read_b128 v[16:19], v200
    v_add_u32 v200, 64, v200
    ds_read_b128 v[20:23], v201
    v_add_u32 v201, 64, v201
    ds_read_b128 v[24:27], v202
    v_add_u32 v202, 64, v202
    ds_read_b128 v[28:31], v203
    v_add_u32 v203, 64, v203
    ds_read_b128 v[32:35], v204
    v_add_u32 v204, 64, v204
    ds_read_b128 v[36:39], v205
    v_add_u32 v205, 64, v205
    ds_read_b128 v[40:43], v206
    v_add_u32 v206, 64, v206
    ds_read_b128 v[44:47], v207
    v_add_u32 v207, 64, v207
    s_add_u32 s26, s26, 64
    s_add_u32 s27, s27, 1024
    s_waitcnt vmcnt(2) lgkmcnt(8)
    v_mfma_f32_16x16x32_bf16 v[96:99], v[48:51], v[88:91], v[96:99]
    v_mfma_f32_16x16x32_bf16 v[100:103], v[52:55], v[88:91], v[100:103]
    v_mfma_f32_16x16x32_bf16 v[104:107], v[56:59], v[88:91], v[104:107]
    v_mfma_f32_16x16x32_bf16 v[108:111], v[60:63], v[88:91], v[108:111]
    v_mfma_f32_16x16x32_bf16 v[112:115], v[64:67], v[88:91], v[112:115]
    v_mfma_f32_16x16x32_bf16 v[116:119], v[68:71], v[88:91], v[116:119]
    v_mfma_f32_16x16x32_bf16 v[120:123], v[72:75], v[88:91], v[120:123]
    v_mfma_f32_16x16x32_bf16 v[124:127], v[76:79], v[88:91], v[124:127]
    v_mfma_f32_16x16x32_bf16 v[128:131], v[48:51], v[92:95], v[128:131]
    v_mfma_f32_16x16x32_bf16 v[132:135], v[52:55], v[92:95], v[132:135]
    v_mfma_f32_16x16x32_bf16 v[136:139], v[56:59], v[92:95], v[136:139]
    v_mfma_f32_16x16x32_bf16 v[140:143], v[60:63], v[92:95], v[140:143]
    v_mfma_f32_16x16x32_bf16 v[144:147], v[64:67], v[92:95], v[144:147]
    v_mfma_f32_16x16x32_bf16 v[148:151], v[68:71], v[92:95], v[148:151]
    v_mfma_f32_16x16x32_bf16 v[152:155], v[72:75], v[92:95], v[152:155]
    v_mfma_f32_16x16x32_bf16 v[156:159], v[76:79], v[92:95], v[156:159]
    s_sub_u32 s28, s28, 1
    s_cmp_lg_u32 s28, 0
    s_cbranch_scc1 .gl74
    s_waitcnt vmcnt(0) lgkmcnt(0)
    s_nop 7
    s_nop 7
    s_sub_u32 s25, s22, 512
    s_lshl_b32 s25, s25, 4
    v_add_u32 v4, s25, v2
    v_lshlrev_b32 v4, 12, v4
    s_lshl_b32 s25, s47, 1
    v_lshl_add_u32 v4, v3, 3, v4
    v_add_u32 v4, s25, v4
    v_add_u32 v4, 0x3800000, v4

    v_cvt_pk_bf16_f32 v16, v96, v97
    v_cvt_pk_bf16_f32 v17, v98, v99
    buffer_store_dwordx2 v[16:17], v4, s[8:11], 0 offen offset:0 sc1
    s_nop 1
    v_cvt_pk_bf16_f32 v18, v100, v101
    v_cvt_pk_bf16_f32 v19, v102, v103
    buffer_store_dwordx2 v[18:19], v4, s[8:11], 0 offen offset:32 sc1
    s_nop 1
    v_cvt_pk_bf16_f32 v16, v104, v105
    v_cvt_pk_bf16_f32 v17, v106, v107
    buffer_store_dwordx2 v[16:17], v4, s[8:11], 0 offen offset:64 sc1
    s_nop 1
    v_cvt_pk_bf16_f32 v18, v108, v109
    v_cvt_pk_bf16_f32 v19, v110, v111
    buffer_store_dwordx2 v[18:19], v4, s[8:11], 0 offen offset:96 sc1
    s_nop 1
    v_cvt_pk_bf16_f32 v16, v112, v113
    v_cvt_pk_bf16_f32 v17, v114, v115
    buffer_store_dwordx2 v[16:17], v4, s[8:11], 0 offen offset:128 sc1
    s_nop 1
    v_cvt_pk_bf16_f32 v18, v116, v117
    v_cvt_pk_bf16_f32 v19, v118, v119
    buffer_store_dwordx2 v[18:19], v4, s[8:11], 0 offen offset:160 sc1
    s_nop 1
    v_cvt_pk_bf16_f32 v16, v120, v121
    v_cvt_pk_bf16_f32 v17, v122, v123
    buffer_store_dwordx2 v[16:17], v4, s[8:11], 0 offen offset:192 sc1
    s_nop 1
    v_cvt_pk_bf16_f32 v18, v124, v125
    v_cvt_pk_bf16_f32 v19, v126, v127
    buffer_store_dwordx2 v[18:19], v4, s[8:11], 0 offen offset:224 sc1
    s_nop 1
    v_add_u32 v4, 0x10000, v4
    v_cvt_pk_bf16_f32 v16, v128, v129
    v_cvt_pk_bf16_f32 v17, v130, v131
    buffer_store_dwordx2 v[16:17], v4, s[8:11], 0 offen offset:0 sc1
    s_nop 1
    v_cvt_pk_bf16_f32 v18, v132, v133
    v_cvt_pk_bf16_f32 v19, v134, v135
    buffer_store_dwordx2 v[18:19], v4, s[8:11], 0 offen offset:32 sc1
    s_nop 1
    v_cvt_pk_bf16_f32 v16, v136, v137
    v_cvt_pk_bf16_f32 v17, v138, v139
    buffer_store_dwordx2 v[16:17], v4, s[8:11], 0 offen offset:64 sc1
    s_nop 1
    v_cvt_pk_bf16_f32 v18, v140, v141
    v_cvt_pk_bf16_f32 v19, v142, v143
    buffer_store_dwordx2 v[18:19], v4, s[8:11], 0 offen offset:96 sc1
    s_nop 1
    v_cvt_pk_bf16_f32 v16, v144, v145
    v_cvt_pk_bf16_f32 v17, v146, v147
    buffer_store_dwordx2 v[16:17], v4, s[8:11], 0 offen offset:128 sc1
    s_nop 1
    v_cvt_pk_bf16_f32 v18, v148, v149
    v_cvt_pk_bf16_f32 v19, v150, v151
    buffer_store_dwordx2 v[18:19], v4, s[8:11], 0 offen offset:160 sc1
    s_nop 1
    v_cvt_pk_bf16_f32 v16, v152, v153
    v_cvt_pk_bf16_f32 v17, v154, v155
    buffer_store_dwordx2 v[16:17], v4, s[8:11], 0 offen offset:192 sc1
    s_nop 1
    v_cvt_pk_bf16_f32 v18, v156, v157
    v_cvt_pk_bf16_f32 v19, v158, v159
    buffer_store_dwordx2 v[18:19], v4, s[8:11], 0 offen offset:224 sc1
    s_nop 1
.wdn72:
    s_waitcnt vmcnt(0)
    s_barrier
    s_cmp_lg_u32 s24, 0
    s_cbranch_scc1 .gnf75
    s_cmp_ge_u32 s43, 512
    s_cbranch_scc1 .gy76
    s_cmp_lg_u32 s42, 0
    s_cbranch_scc1 .gnf75
.gy76:
    v_mov_b32 v4, s48
    v_mov_b32 v5, 1
    s_mov_b64 exec, 1
    buffer_store_dword v5, v4, s[8:11], 0 offen sc1
    s_mov_b64 exec, -1
.gnf75:
    s_add_u32 s43, s43, 224
    s_branch .gt67
.gdone70:
    s_mov_b32 s49, 0
    s_mov_b32 s43, s29
    s_mov_b32 s42, 40
    s_mov_b32 s39, 256
    s_cmp_lt_u32 s29, 40
    s_cbranch_scc1 .pt77
    s_mov_b32 s49, 1
    s_sub_u32 s43, s29, 40
    s_mov_b32 s42, 104
    s_mov_b32 s39, 1024
    s_cmp_lt_u32 s29, 144
    s_cbranch_scc1 .pt77
    s_mov_b32 s49, 2
    s_sub_u32 s43, s29, 144
    s_mov_b32 s42, 40
    s_mov_b32 s39, 896
    s_cmp_lt_u32 s29, 184
    s_cbranch_scc1 .pt77
    s_mov_b32 s49, 3
    s_sub_u32 s43, s29, 184
    s_mov_b32 s42, 40
    s_mov_b32 s39, 1024

.pt77:
    s_cmp_ge_u32 s43, s39
    s_cbranch_scc1 .mend12
    s_lshr_b32 s44, s43, 2
    s_and_b32 s45, s43, 3
    s_cmp_eq_u32 s49, 0
    s_cbranch_scc1 .pA78
    s_lshr_b32 s44, s43, 4
    s_and_b32 s45, s43, 15
    s_cmp_eq_u32 s49, 1
    s_cbranch_scc1 .pW79
    s_cmp_eq_u32 s49, 3
    s_cbranch_scc1 .pF281
    s_mul_i32 s44, s43, 4682
    s_lshr_b32 s44, s44, 16
    s_mul_i32 s45, s44, 14
    s_sub_u32 s45, s43, s45
    s_branch .pF180

.pA78:
    s_mov_b32 s23, s44
    s_lshl_b32 s46, s23, 2
    s_add_u32 s46, s46, s45
    s_lshl_b32 s46, s46, 2
    s_add_u32 s46, s46, 0x7104000
    s_lshl_b32 s22, s45, 3
    s_add_u32 s22, s22, s20
    s_lshl_b32 s21, s23, 5
    s_add_u32 s21, s21, s22
    s_lshl_b32 s21, s21, 2
    s_add_u32 s21, s21, 0x7102000

    v_mov_b32 v16, s21
    s_mov_b32 s37, 0
.wf87:
    buffer_load_dword v17, v16, s[8:11], 0 offen sc1
    s_waitcnt vmcnt(0)
    v_readfirstlane_b32 s38, v17
    s_add_u32 s37, s37, 1
    s_cmp_lg_u32 s38, 0
    s_cbranch_scc1 .wfd88
    s_sleep 2
    s_cmp_lt_u32 s37, 1048576
    s_cbranch_scc1 .wf87
.wfd88:
    s_lshr_b32 s21, s23, 2
    s_lshl_b32 s21, s21, 5
    s_add_u32 s21, s21, s22
    s_lshl_b32 s21, s21, 2
    s_add_u32 s47, s21, 0x7101000
    s_add_u32 s21, s21, 0x7100000

    v_mov_b32 v16, s21
    s_mov_b32 s37, 0
.wf89:
    buffer_load_dword v17, v16, s[8:11], 0 offen sc1
    s_waitcnt vmcnt(0)
    v_readfirstlane_b32 s38, v17
    s_add_u32 s37, s37, 1
    s_cmp_lg_u32 s38, 0
    s_cbranch_scc1 .wfd90
    s_sleep 2
    s_cmp_lt_u32 s37, 1048576
    s_cbranch_scc1 .wf89
.wfd90:
    v_mov_b32 v16, s47
    s_mov_b32 s37, 0
.wf91:
    buffer_load_dword v17, v16, s[8:11], 0 offen sc1
    s_waitcnt vmcnt(0)
    v_readfirstlane_b32 s38, v17
    s_add_u32 s37, s37, 1
    s_cmp_lg_u32 s38, 0
    s_cbranch_scc1 .wfd92
    s_sleep 2
    s_cmp_lt_u32 s37, 1048576
    s_cbranch_scc1 .wf91
.wfd92:
    v_and_b32 v4, 7, v1
    s_lshl_b32 s24, s23, 19
    s_lshl_b32 s25, s22, 8
    s_add_u32 s24, s24, s25
    s_add_u32 s24, s24, 0x1800000
    v_lshlrev_b32 v5, 14, v2
    v_lshl_add_u32 v5, v3, 4, v5
    v_add_u32 v5, s24, v5
    v_add_u32 v6, 0x40000, v5
    s_lshl_b32 s24, s23, 16
    s_add_u32 s24, s24, s25
    s_add_u32 s24, s24, 0x4800000
    v_lshlrev_b32 v7, 13, v4
    v_lshl_add_u32 v7, v3, 4, v7
    v_add_u32 v7, s24, v7

    buffer_load_dwordx4 v[16:19], v5, s[8:11], 0 offen offset:0 sc1
    buffer_load_dwordx4 v[20:23], v5, s[8:11], 0 offen offset:64 sc1
    buffer_load_dwordx4 v[24:27], v5, s[8:11], 0 offen offset:128 sc1
    buffer_load_dwordx4 v[28:31], v5, s[8:11], 0 offen offset:192 sc1
    buffer_load_dwordx4 v[32:35], v6, s[8:11], 0 offen offset:0 sc1
    buffer_load_dwordx4 v[36:39], v6, s[8:11], 0 offen offset:64 sc1
    buffer_load_dwordx4 v[40:43], v6, s[8:11], 0 offen offset:128 sc1
    buffer_load_dwordx4 v[44:47], v6, s[8:11], 0 offen offset:192 sc1
    buffer_load_dwordx4 v[48:51], v7, s[8:11], 0 offen offset:0 sc1
    buffer_load_dwordx4 v[52:55], v7, s[8:11], 0 offen offset:64 sc1
    buffer_load_dwordx4 v[56:59], v7, s[8:11], 0 offen offset:128 sc1
    buffer_load_dwordx4 v[60:63], v7, s[8:11], 0 offen offset:192 sc1
    v_add_u32 v8, 0x2000, v5
    v_add_u32 v9, 0x2000, v6
    buffer_load_dwordx4 v[64:67], v8, s[8:11], 0 offen offset:0 sc1
    buffer_load_dwordx4 v[68:71], v8, s[8:11], 0 offen offset:64 sc1
    buffer_load_dwordx4 v[72:75], v8, s[8:11], 0 offen offset:128 sc1
    buffer_load_dwordx4 v[76:79], v8, s[8:11], 0 offen offset:192 sc1
    buffer_load_dwordx4 v[80:83], v9, s[8:11], 0 offen offset:0 sc1
    buffer_load_dwordx4 v[84:87], v9, s[8:11], 0 offen offset:64 sc1
    buffer_load_dwordx4 v[88:91], v9, s[8:11], 0 offen offset:128 sc1
    buffer_load_dwordx4 v[92:95], v9, s[8:11], 0 offen offset:192 sc1
    v_mov_b32 v96, 0
    v_mov_b32 v97, 0
    v_mov_b32 v98, 0
    v_mov_b32 v99, 0
    v_mov_b32 v100, 0
    v_mov_b32 v101, 0
    v_mov_b32 v102, 0
    v_mov_b32 v103, 0
    v_mov_b32 v104, 0
    v_mov_b32 v105, 0
    v_mov_b32 v106, 0
    v_mov_b32 v107, 0
    v_mov_b32 v108, 0
    v_mov_b32 v109, 0
    v_mov_b32 v110, 0
    v_mov_b32 v111, 0
    v_mov_b32 v112, 0
    v_mov_b32 v113, 0
    v_mov_b32 v114, 0
    v_mov_b32 v115, 0
    v_mov_b32 v116, 0
    v_mov_b32 v117, 0
    v_mov_b32 v118, 0
    v_mov_b32 v119, 0
    s_waitcnt vmcnt(0)
    v_mfma_f32_16x16x32_bf16 v[96:99], v[48:51], v[16:19], v[96:99]
    v_mfma_f32_16x16x32_bf16 v[96:99], v[52:55], v[20:23], v[96:99]
    v_mfma_f32_16x16x32_bf16 v[96:99], v[56:59], v[24:27], v[96:99]
    v_mfma_f32_16x16x32_bf16 v[96:99], v[60:63], v[28:31], v[96:99]
    v_mfma_f32_16x16x32_bf16 v[100:103], v[48:51], v[32:35], v[100:103]
    v_mfma_f32_16x16x32_bf16 v[100:103], v[52:55], v[36:39], v[100:103]
    v_mfma_f32_16x16x32_bf16 v[100:103], v[56:59], v[40:43], v[100:103]
    v_mfma_f32_16x16x32_bf16 v[100:103], v[60:63], v[44:47], v[100:103]
    v_mfma_f32_16x16x32_bf16 v[104:107], v[64:67], v[16:19], v[104:107]
    v_mfma_f32_16x16x32_bf16 v[104:107], v[68:71], v[20:23], v[104:107]
    v_mfma_f32_16x16x32_bf16 v[104:107], v[72:75], v[24:27], v[104:107]
    v_mfma_f32_16x16x32_bf16 v[104:107], v[76:79], v[28:31], v[104:107]
    v_mfma_f32_16x16x32_bf16 v[108:111], v[64:67], v[32:35], v[108:111]
    v_mfma_f32_16x16x32_bf16 v[108:111], v[68:71], v[36:39], v[108:111]
    v_mfma_f32_16x16x32_bf16 v[108:111], v[72:75], v[40:43], v[108:111]
    v_mfma_f32_16x16x32_bf16 v[108:111], v[76:79], v[44:47], v[108:111]
    v_mfma_f32_16x16x32_bf16 v[112:115], v[80:83], v[16:19], v[112:115]
    v_mfma_f32_16x16x32_bf16 v[112:115], v[84:87], v[20:23], v[112:115]
    v_mfma_f32_16x16x32_bf16 v[112:115], v[88:91], v[24:27], v[112:115]
    v_mfma_f32_16x16x32_bf16 v[112:115], v[92:95], v[28:31], v[112:115]
    v_mfma_f32_16x16x32_bf16 v[116:119], v[80:83], v[32:35], v[116:119]
    v_mfma_f32_16x16x32_bf16 v[116:119], v[84:87], v[36:39], v[116:119]
    v_mfma_f32_16x16x32_bf16 v[116:119], v[88:91], v[40:43], v[116:119]
    v_mfma_f32_16x16x32_bf16 v[116:119], v[92:95], v[44:47], v[116:119]
    s_nop 7
    s_nop 1
    s_lshl_b32 s24, s23, 16
    s_lshl_b32 s25, s22, 11
    s_add_u32 s24, s24, s25
    s_add_u32 s24, s24, 0x4c00000
    v_and_b32 v10, 1, v3
    v_lshlrev_b32 v10, 3, v10
    v_lshl_add_u32 v10, v2, 4, v10
    v_add_u32 v10, s24, v10
    s_lshl_b32 s24, s22, 19
    s_lshl_b32 s25, s23, 6
    s_add_u32 s24, s24, s25
    s_add_u32 s24, s24, 0x3800000
    v_lshlrev_b32 v11, 12, v2
    v_lshl_add_u32 v11, v3, 3, v11
    v_add_u32 v11, s24, v11

    buffer_load_dwordx2 v[16:17], v10, s[8:11], 0 offen offset:0 sc1
    buffer_load_dwordx2 v[18:19], v11, s[8:11], 0 offen sc1
    buffer_load_dwordx2 v[20:21], v11, s[8:11], 0 offen offset:32 sc1
    v_add_u32 v11, 0x10000, v11
    buffer_load_dwordx2 v[22:23], v10, s[8:11], 0 offen offset:256 sc1
    buffer_load_dwordx2 v[24:25], v11, s[8:11], 0 offen sc1
    buffer_load_dwordx2 v[26:27], v11, s[8:11], 0 offen offset:32 sc1
    v_add_u32 v11, 0x10000, v11
    buffer_load_dwordx2 v[28:29], v10, s[8:11], 0 offen offset:512 sc1
    buffer_load_dwordx2 v[30:31], v11, s[8:11], 0 offen sc1
    buffer_load_dwordx2 v[32:33], v11, s[8:11], 0 offen offset:32 sc1
    v_add_u32 v11, 0x10000, v11
    buffer_load_dwordx2 v[34:35], v10, s[8:11], 0 offen offset:768 sc1
    buffer_load_dwordx2 v[36:37], v11, s[8:11], 0 offen sc1
    buffer_load_dwordx2 v[38:39], v11, s[8:11], 0 offen offset:32 sc1
    v_add_u32 v11, 0x10000, v11
    buffer_load_dwordx2 v[40:41], v10, s[8:11], 0 offen offset:1024 sc1
    buffer_load_dwordx2 v[42:43], v11, s[8:11], 0 offen sc1
    buffer_load_dwordx2 v[44:45], v11, s[8:11], 0 offen offset:32 sc1
    v_add_u32 v11, 0x10000, v11
    buffer_load_dwordx2 v[46:47], v10, s[8:11], 0 offen offset:1280 sc1
    buffer_load_dwordx2 v[48:49], v11, s[8:11], 0 offen sc1
    buffer_load_dwordx2 v[50:51], v11, s[8:11], 0 offen offset:32 sc1
    v_add_u32 v11, 0x10000, v11
    buffer_load_dwordx2 v[52:53], v10, s[8:11], 0 offen offset:1536 sc1
    buffer_load_dwordx2 v[54:55], v11, s[8:11], 0 offen sc1
    buffer_load_dwordx2 v[56:57], v11, s[8:11], 0 offen offset:32 sc1
    v_add_u32 v11, 0x10000, v11
    buffer_load_dwordx2 v[58:59], v10, s[8:11], 0 offen offset:1792 sc1
    buffer_load_dwordx2 v[60:61], v11, s[8:11], 0 offen sc1
    buffer_load_dwordx2 v[62:63], v11, s[8:11], 0 offen offset:32 sc1
    v_lshlrev_b32 v12, 2, v3
    v_sub_u32 v12, v2, v12
    v_cmp_gt_u32 s[40:41], 2, v3
    v_mov_b32 v13, 0xff800000
    v_cvt_pk_bf16_f32 v14, v96, v97
    v_lshlrev_b32 v96, 16, v14
    v_and_b32 v97, 0xffff0000, v14
    v_mul_f32 v96, 0x3db504f3, v96
    v_mul_f32 v97, 0x3db504f3, v97
    v_cvt_pk_bf16_f32 v14, v96, v97
    v_lshlrev_b32 v96, 16, v14
    v_and_b32 v97, 0xffff0000, v14
    v_cvt_pk_bf16_f32 v14, v98, v99
    v_lshlrev_b32 v98, 16, v14
    v_and_b32 v99, 0xffff0000, v14
    v_mul_f32 v98, 0x3db504f3, v98
    v_mul_f32 v99, 0x3db504f3, v99
    v_cvt_pk_bf16_f32 v14, v98, v99
    v_lshlrev_b32 v98, 16, v14
    v_and_b32 v99, 0xffff0000, v14
    v_cvt_pk_bf16_f32 v14, v104, v105
    v_lshlrev_b32 v104, 16, v14
    v_and_b32 v105, 0xffff0000, v14
    v_mul_f32 v104, 0x3db504f3, v104
    v_mul_f32 v105, 0x3db504f3, v105
    v_cvt_pk_bf16_f32 v14, v104, v105
    v_lshlrev_b32 v104, 16, v14
    v_and_b32 v105, 0xffff0000, v14
    v_cvt_pk_bf16_f32 v14, v106, v107
    v_lshlrev_b32 v106, 16, v14
    v_and_b32 v107, 0xffff0000, v14
    v_mul_f32 v106, 0x3db504f3, v106
    v_mul_f32 v107, 0x3db504f3, v107
    v_cvt_pk_bf16_f32 v14, v106, v107
    v_lshlrev_b32 v106, 16, v14
    v_and_b32 v107, 0xffff0000, v14
    v_cvt_pk_bf16_f32 v14, v112, v113
    v_lshlrev_b32 v112, 16, v14
    v_and_b32 v113, 0xffff0000, v14
    v_mul_f32 v112, 0x3db504f3, v112
    v_mul_f32 v113, 0x3db504f3, v113
    v_cvt_pk_bf16_f32 v14, v112, v113
    v_lshlrev_b32 v112, 16, v14
    v_and_b32 v113, 0xffff0000, v14
    v_cvt_pk_bf16_f32 v14, v114, v115
    v_lshlrev_b32 v114, 16, v14
    v_and_b32 v115, 0xffff0000, v14
    v_mul_f32 v114, 0x3db504f3, v114
    v_mul_f32 v115, 0x3db504f3, v115
    v_cvt_pk_bf16_f32 v14, v114, v115
    v_lshlrev_b32 v114, 16, v14
    v_and_b32 v115, 0xffff0000, v14
    v_cndmask_b32 v96, v13, v96, s[40:41]
    v_cndmask_b32 v97, v13, v97, s[40:41]
    v_cndmask_b32 v98, v13, v98, s[40:41]
    v_cndmask_b32 v99, v13, v99, s[40:41]
    v_cmp_le_i32 vcc, 0, v12
    s_nop 1
    v_cndmask_b32 v104, v13, v104, vcc
    v_cmp_le_i32 vcc, 1, v12
    s_nop 1
    v_cndmask_b32 v105, v13, v105, vcc
    v_cmp_le_i32 vcc, 2, v12
    s_nop 1
    v_cndmask_b32 v106, v13, v106, vcc
    v_cmp_le_i32 vcc, 3, v12
    s_nop 1
    v_cndmask_b32 v107, v13, v107, vcc
    v_cmp_le_i32 vcc, 16, v12
    s_nop 1
    v_cndmask_b32 v112, v13, v112, vcc
    v_cmp_le_i32 vcc, 17, v12
    s_nop 1
    v_cndmask_b32 v113, v13, v113, vcc
    v_cmp_le_i32 vcc, 18, v12
    s_nop 1
    v_cndmask_b32 v114, v13, v114, vcc
    v_cmp_le_i32 vcc, 19, v12
    s_nop 1
    v_cndmask_b32 v115, v13, v115, vcc
    v_max_f32 v14, v96, v97
    v_max_f32 v14, v14, v98
    v_max_f32 v14, v14, v99
    v_max_f32 v14, v14, v104
    v_max_f32 v14, v14, v105
    v_max_f32 v14, v14, v106
    v_max_f32 v14, v14, v107
    v_max_f32 v14, v14, v112
    v_max_f32 v14, v14, v113
    v_max_f32 v14, v14, v114
    v_max_f32 v14, v14, v115
    v_mov_b32 v90, v14
    s_nop 1
    v_permlane16_swap_b32 v14, v90
    s_nop 1
    v_max_f32 v14, v14, v90
    v_mov_b32 v90, v14
    s_nop 1
    v_permlane32_swap_b32 v14, v90
    s_nop 1
    v_max_f32 v14, v14, v90
    v_sub_f32 v96, v96, v14
    v_mul_f32 v96, 0x3fb8aa3b, v96
    v_exp_f32 v96, v96
    v_sub_f32 v97, v97, v14
    v_mul_f32 v97, 0x3fb8aa3b, v97
    v_exp_f32 v97, v97
    v_sub_f32 v98, v98, v14
    v_mul_f32 v98, 0x3fb8aa3b, v98
    v_exp_f32 v98, v98
    v_sub_f32 v99, v99, v14
    v_mul_f32 v99, 0x3fb8aa3b, v99
    v_exp_f32 v99, v99
    v_sub_f32 v104, v104, v14
    v_mul_f32 v104, 0x3fb8aa3b, v104
    v_exp_f32 v104, v104
    v_sub_f32 v105, v105, v14
    v_mul_f32 v105, 0x3fb8aa3b, v105
    v_exp_f32 v105, v105
    v_sub_f32 v106, v106, v14
    v_mul_f32 v106, 0x3fb8aa3b, v106
    v_exp_f32 v106, v106
    v_sub_f32 v107, v107, v14
    v_mul_f32 v107, 0x3fb8aa3b, v107
    v_exp_f32 v107, v107
    v_sub_f32 v112, v112, v14
    v_mul_f32 v112, 0x3fb8aa3b, v112
    v_exp_f32 v112, v112
    v_sub_f32 v113, v113, v14
    v_mul_f32 v113, 0x3fb8aa3b, v113
    v_exp_f32 v113, v113
    v_sub_f32 v114, v114, v14
    v_mul_f32 v114, 0x3fb8aa3b, v114
    v_exp_f32 v114, v114
    v_sub_f32 v115, v115, v14
    v_mul_f32 v115, 0x3fb8aa3b, v115
    v_exp_f32 v115, v115
    s_nop 0
    v_add_f32 v15, v96, v97
    v_add_f32 v15, v15, v98
    v_add_f32 v15, v15, v99
    v_add_f32 v15, v15, v104
    v_add_f32 v15, v15, v105
    v_add_f32 v15, v15, v106
    v_add_f32 v15, v15, v107
    v_add_f32 v15, v15, v112
    v_add_f32 v15, v15, v113
    v_add_f32 v15, v15, v114
    v_add_f32 v15, v15, v115
    v_mov_b32 v90, v15
    s_nop 1
    v_permlane16_swap_b32 v15, v90
    s_nop 1
    v_add_f32 v15, v15, v90
    v_mov_b32 v90, v15
    s_nop 1
    v_permlane32_swap_b32 v15, v90
    s_nop 1
    v_add_f32 v15, v15, v90
    v_rcp_f32 v15, v15
    s_nop 0
    v_mul_f32 v96, v96, v15
    v_mul_f32 v97, v97, v15
    v_mul_f32 v98, v98, v15
    v_mul_f32 v99, v99, v15
    v_mul_f32 v104, v104, v15
    v_mul_f32 v105, v105, v15
    v_mul_f32 v106, v106, v15
    v_mul_f32 v107, v107, v15
    v_mul_f32 v112, v112, v15
    v_mul_f32 v113, v113, v15
    v_mul_f32 v114, v114, v15
    v_mul_f32 v115, v115, v15
    v_cvt_pk_bf16_f32 v64, v96, v97
    v_cvt_pk_bf16_f32 v65, v98, v99
    v_cvt_pk_bf16_f32 v66, v104, v105
    v_cvt_pk_bf16_f32 v67, v106, v107
    v_cvt_pk_bf16_f32 v68, v112, v113
    v_cvt_pk_bf16_f32 v69, v114, v115
    v_cvt_pk_bf16_f32 v14, v100, v101
    v_lshlrev_b32 v100, 16, v14
    v_and_b32 v101, 0xffff0000, v14
    v_mul_f32 v100, 0x3db504f3, v100
    v_mul_f32 v101, 0x3db504f3, v101
    v_cvt_pk_bf16_f32 v14, v100, v101
    v_lshlrev_b32 v100, 16, v14
    v_and_b32 v101, 0xffff0000, v14
    v_cvt_pk_bf16_f32 v14, v102, v103
    v_lshlrev_b32 v102, 16, v14
    v_and_b32 v103, 0xffff0000, v14
    v_mul_f32 v102, 0x3db504f3, v102
    v_mul_f32 v103, 0x3db504f3, v103
    v_cvt_pk_bf16_f32 v14, v102, v103
    v_lshlrev_b32 v102, 16, v14
    v_and_b32 v103, 0xffff0000, v14
    v_cvt_pk_bf16_f32 v14, v108, v109
    v_lshlrev_b32 v108, 16, v14
    v_and_b32 v109, 0xffff0000, v14
    v_mul_f32 v108, 0x3db504f3, v108
    v_mul_f32 v109, 0x3db504f3, v109
    v_cvt_pk_bf16_f32 v14, v108, v109
    v_lshlrev_b32 v108, 16, v14
    v_and_b32 v109, 0xffff0000, v14
    v_cvt_pk_bf16_f32 v14, v110, v111
    v_lshlrev_b32 v110, 16, v14
    v_and_b32 v111, 0xffff0000, v14
    v_mul_f32 v110, 0x3db504f3, v110
    v_mul_f32 v111, 0x3db504f3, v111
    v_cvt_pk_bf16_f32 v14, v110, v111
    v_lshlrev_b32 v110, 16, v14
    v_and_b32 v111, 0xffff0000, v14
    v_cvt_pk_bf16_f32 v14, v116, v117
    v_lshlrev_b32 v116, 16, v14
    v_and_b32 v117, 0xffff0000, v14
    v_mul_f32 v116, 0x3db504f3, v116
    v_mul_f32 v117, 0x3db504f3, v117
    v_cvt_pk_bf16_f32 v14, v116, v117
    v_lshlrev_b32 v116, 16, v14
    v_and_b32 v117, 0xffff0000, v14
    v_cvt_pk_bf16_f32 v14, v118, v119
    v_lshlrev_b32 v118, 16, v14
    v_and_b32 v119, 0xffff0000, v14
    v_mul_f32 v118, 0x3db504f3, v118
    v_mul_f32 v119, 0x3db504f3, v119
    v_cvt_pk_bf16_f32 v14, v118, v119
    v_lshlrev_b32 v118, 16, v14
    v_and_b32 v119, 0xffff0000, v14
    v_cndmask_b32 v100, v13, v100, s[40:41]
    v_cndmask_b32 v101, v13, v101, s[40:41]
    v_cndmask_b32 v102, v13, v102, s[40:41]
    v_cndmask_b32 v103, v13, v103, s[40:41]
    v_cmp_le_i32 vcc, -16, v12
    s_nop 1
    v_cndmask_b32 v108, v13, v108, vcc
    v_cmp_le_i32 vcc, -15, v12
    s_nop 1
    v_cndmask_b32 v109, v13, v109, vcc
    v_cmp_le_i32 vcc, -14, v12
    s_nop 1
    v_cndmask_b32 v110, v13, v110, vcc
    v_cmp_le_i32 vcc, -13, v12
    s_nop 1
    v_cndmask_b32 v111, v13, v111, vcc
    v_cmp_le_i32 vcc, 0, v12
    s_nop 1
    v_cndmask_b32 v116, v13, v116, vcc
    v_cmp_le_i32 vcc, 1, v12
    s_nop 1
    v_cndmask_b32 v117, v13, v117, vcc
    v_cmp_le_i32 vcc, 2, v12
    s_nop 1
    v_cndmask_b32 v118, v13, v118, vcc
    v_cmp_le_i32 vcc, 3, v12
    s_nop 1
    v_cndmask_b32 v119, v13, v119, vcc
    v_max_f32 v14, v100, v101
    v_max_f32 v14, v14, v102
    v_max_f32 v14, v14, v103
    v_max_f32 v14, v14, v108
    v_max_f32 v14, v14, v109
    v_max_f32 v14, v14, v110
    v_max_f32 v14, v14, v111
    v_max_f32 v14, v14, v116
    v_max_f32 v14, v14, v117
    v_max_f32 v14, v14, v118
    v_max_f32 v14, v14, v119
    v_mov_b32 v90, v14
    s_nop 1
    v_permlane16_swap_b32 v14, v90
    s_nop 1
    v_max_f32 v14, v14, v90
    v_mov_b32 v90, v14
    s_nop 1
    v_permlane32_swap_b32 v14, v90
    s_nop 1
    v_max_f32 v14, v14, v90
    v_sub_f32 v100, v100, v14
    v_mul_f32 v100, 0x3fb8aa3b, v100
    v_exp_f32 v100, v100
    v_sub_f32 v101, v101, v14
    v_mul_f32 v101, 0x3fb8aa3b, v101
    v_exp_f32 v101, v101
    v_sub_f32 v102, v102, v14
    v_mul_f32 v102, 0x3fb8aa3b, v102
    v_exp_f32 v102, v102
    v_sub_f32 v103, v103, v14
    v_mul_f32 v103, 0x3fb8aa3b, v103
    v_exp_f32 v103, v103
    v_sub_f32 v108, v108, v14
    v_mul_f32 v108, 0x3fb8aa3b, v108
    v_exp_f32 v108, v108
    v_sub_f32 v109, v109, v14
    v_mul_f32 v109, 0x3fb8aa3b, v109
    v_exp_f32 v109, v109
    v_sub_f32 v110, v110, v14
    v_mul_f32 v110, 0x3fb8aa3b, v110
    v_exp_f32 v110, v110
    v_sub_f32 v111, v111, v14
    v_mul_f32 v111, 0x3fb8aa3b, v111
    v_exp_f32 v111, v111
    v_sub_f32 v116, v116, v14
    v_mul_f32 v116, 0x3fb8aa3b, v116
    v_exp_f32 v116, v116
    v_sub_f32 v117, v117, v14
    v_mul_f32 v117, 0x3fb8aa3b, v117
    v_exp_f32 v117, v117
    v_sub_f32 v118, v118, v14
    v_mul_f32 v118, 0x3fb8aa3b, v118
    v_exp_f32 v118, v118
    v_sub_f32 v119, v119, v14
    v_mul_f32 v119, 0x3fb8aa3b, v119
    v_exp_f32 v119, v119
    s_nop 0
    v_add_f32 v15, v100, v101
    v_add_f32 v15, v15, v102
    v_add_f32 v15, v15, v103
    v_add_f32 v15, v15, v108
    v_add_f32 v15, v15, v109
    v_add_f32 v15, v15, v110
    v_add_f32 v15, v15, v111
    v_add_f32 v15, v15, v116
    v_add_f32 v15, v15, v117
    v_add_f32 v15, v15, v118
    v_add_f32 v15, v15, v119
    v_mov_b32 v90, v15
    s_nop 1
    v_permlane16_swap_b32 v15, v90
    s_nop 1
    v_add_f32 v15, v15, v90
    v_mov_b32 v90, v15
    s_nop 1
    v_permlane32_swap_b32 v15, v90
    s_nop 1
    v_add_f32 v15, v15, v90
    v_rcp_f32 v15, v15
    s_nop 0
    v_mul_f32 v100, v100, v15
    v_mul_f32 v101, v101, v15
    v_mul_f32 v102, v102, v15
    v_mul_f32 v103, v103, v15
    v_mul_f32 v108, v108, v15
    v_mul_f32 v109, v109, v15
    v_mul_f32 v110, v110, v15
    v_mul_f32 v111, v111, v15
    v_mul_f32 v116, v116, v15
    v_mul_f32 v117, v117, v15
    v_mul_f32 v118, v118, v15
    v_mul_f32 v119, v119, v15
    v_cvt_pk_bf16_f32 v70, v100, v101
    v_cvt_pk_bf16_f32 v71, v102, v103
    v_cvt_pk_bf16_f32 v72, v108, v109
    v_cvt_pk_bf16_f32 v73, v110, v111
    v_cvt_pk_bf16_f32 v74, v116, v117
    v_cvt_pk_bf16_f32 v75, v118, v119
    s_lshl_b32 s24, s23, 18
    s_lshl_b32 s25, s22, 8
    s_add_u32 s24, s24, s25
    s_add_u32 s24, s24, 0x5000000
    v_lshlrev_b32 v12, 13, v2
    v_lshl_add_u32 v12, v3, 3, v12
    v_add_u32 v12, s24, v12
    v_add_u32 v13, 0x20000, v12
    s_waitcnt vmcnt(0)

    v_mov_b32 v80, 0
    v_mov_b32 v81, 0
    v_mov_b32 v82, 0
    v_mov_b32 v83, 0
    s_nop 1
    v_mfma_f32_16x16x16_bf16 v[80:83], v[16:17], v[64:65], v[80:83]
    s_nop 7
    v_mfma_f32_16x16x32_bf16 v[80:83], v[18:21], v[66:69], v[80:83]
    v_mov_b32 v84, 0
    v_mov_b32 v85, 0
    v_mov_b32 v86, 0
    v_mov_b32 v87, 0
    s_nop 1
    v_mfma_f32_16x16x16_bf16 v[84:87], v[16:17], v[70:71], v[84:87]
    s_nop 7
    v_mfma_f32_16x16x32_bf16 v[84:87], v[18:21], v[72:75], v[84:87]
    s_nop 7
    s_nop 1
    v_cvt_pk_bf16_f32 v88, v80, v81
    v_cvt_pk_bf16_f32 v89, v82, v83
    buffer_store_dwordx2 v[88:89], v12, s[8:11], 0 offen offset:0 sc1
    v_cvt_pk_bf16_f32 v90, v84, v85
    v_cvt_pk_bf16_f32 v91, v86, v87
    buffer_store_dwordx2 v[90:91], v13, s[8:11], 0 offen offset:0 sc1
    s_nop 1
    v_mov_b32 v80, 0
    v_mov_b32 v81, 0
    v_mov_b32 v82, 0
    v_mov_b32 v83, 0
    s_nop 1
    v_mfma_f32_16x16x16_bf16 v[80:83], v[22:23], v[64:65], v[80:83]
    s_nop 7
    v_mfma_f32_16x16x32_bf16 v[80:83], v[24:27], v[66:69], v[80:83]
    v_mov_b32 v84, 0
    v_mov_b32 v85, 0
    v_mov_b32 v86, 0
    v_mov_b32 v87, 0
    s_nop 1
    v_mfma_f32_16x16x16_bf16 v[84:87], v[22:23], v[70:71], v[84:87]
    s_nop 7
    v_mfma_f32_16x16x32_bf16 v[84:87], v[24:27], v[72:75], v[84:87]
    s_nop 7
    s_nop 1
    v_cvt_pk_bf16_f32 v88, v80, v81
    v_cvt_pk_bf16_f32 v89, v82, v83
    buffer_store_dwordx2 v[88:89], v12, s[8:11], 0 offen offset:32 sc1
    v_cvt_pk_bf16_f32 v90, v84, v85
    v_cvt_pk_bf16_f32 v91, v86, v87
    buffer_store_dwordx2 v[90:91], v13, s[8:11], 0 offen offset:32 sc1
    s_nop 1
    v_mov_b32 v80, 0
    v_mov_b32 v81, 0
    v_mov_b32 v82, 0
    v_mov_b32 v83, 0
    s_nop 1
    v_mfma_f32_16x16x16_bf16 v[80:83], v[28:29], v[64:65], v[80:83]
    s_nop 7
    v_mfma_f32_16x16x32_bf16 v[80:83], v[30:33], v[66:69], v[80:83]
    v_mov_b32 v84, 0
    v_mov_b32 v85, 0
    v_mov_b32 v86, 0
    v_mov_b32 v87, 0
    s_nop 1
    v_mfma_f32_16x16x16_bf16 v[84:87], v[28:29], v[70:71], v[84:87]
    s_nop 7
    v_mfma_f32_16x16x32_bf16 v[84:87], v[30:33], v[72:75], v[84:87]
    s_nop 7
    s_nop 1
    v_cvt_pk_bf16_f32 v88, v80, v81
    v_cvt_pk_bf16_f32 v89, v82, v83
    buffer_store_dwordx2 v[88:89], v12, s[8:11], 0 offen offset:64 sc1
    v_cvt_pk_bf16_f32 v90, v84, v85
    v_cvt_pk_bf16_f32 v91, v86, v87
    buffer_store_dwordx2 v[90:91], v13, s[8:11], 0 offen offset:64 sc1
    s_nop 1
    v_mov_b32 v80, 0
    v_mov_b32 v81, 0
    v_mov_b32 v82, 0
    v_mov_b32 v83, 0
    s_nop 1
    v_mfma_f32_16x16x16_bf16 v[80:83], v[34:35], v[64:65], v[80:83]
    s_nop 7
    v_mfma_f32_16x16x32_bf16 v[80:83], v[36:39], v[66:69], v[80:83]
    v_mov_b32 v84, 0
    v_mov_b32 v85, 0
    v_mov_b32 v86, 0
    v_mov_b32 v87, 0
    s_nop 1
    v_mfma_f32_16x16x16_bf16 v[84:87], v[34:35], v[70:71], v[84:87]
    s_nop 7
    v_mfma_f32_16x16x32_bf16 v[84:87], v[36:39], v[72:75], v[84:87]
    s_nop 7
    s_nop 1
    v_cvt_pk_bf16_f32 v88, v80, v81
    v_cvt_pk_bf16_f32 v89, v82, v83
    buffer_store_dwordx2 v[88:89], v12, s[8:11], 0 offen offset:96 sc1
    v_cvt_pk_bf16_f32 v90, v84, v85
    v_cvt_pk_bf16_f32 v91, v86, v87
    buffer_store_dwordx2 v[90:91], v13, s[8:11], 0 offen offset:96 sc1
    s_nop 1
    v_mov_b32 v80, 0
    v_mov_b32 v81, 0
    v_mov_b32 v82, 0
    v_mov_b32 v83, 0
    s_nop 1
    v_mfma_f32_16x16x16_bf16 v[80:83], v[40:41], v[64:65], v[80:83]
    s_nop 7
    v_mfma_f32_16x16x32_bf16 v[80:83], v[42:45], v[66:69], v[80:83]
    v_mov_b32 v84, 0
    v_mov_b32 v85, 0
    v_mov_b32 v86, 0
    v_mov_b32 v87, 0
    s_nop 1
    v_mfma_f32_16x16x16_bf16 v[84:87], v[40:41], v[70:71], v[84:87]
    s_nop 7
    v_mfma_f32_16x16x32_bf16 v[84:87], v[42:45], v[72:75], v[84:87]
    s_nop 7
    s_nop 1
    v_cvt_pk_bf16_f32 v88, v80, v81
    v_cvt_pk_bf16_f32 v89, v82, v83
    buffer_store_dwordx2 v[88:89], v12, s[8:11], 0 offen offset:128 sc1
    v_cvt_pk_bf16_f32 v90, v84, v85
    v_cvt_pk_bf16_f32 v91, v86, v87
    buffer_store_dwordx2 v[90:91], v13, s[8:11], 0 offen offset:128 sc1
    s_nop 1
    v_mov_b32 v80, 0
    v_mov_b32 v81, 0
    v_mov_b32 v82, 0
    v_mov_b32 v83, 0
    s_nop 1
    v_mfma_f32_16x16x16_bf16 v[80:83], v[46:47], v[64:65], v[80:83]
    s_nop 7
    v_mfma_f32_16x16x32_bf16 v[80:83], v[48:51], v[66:69], v[80:83]
    v_mov_b32 v84, 0
    v_mov_b32 v85, 0
    v_mov_b32 v86, 0
    v_mov_b32 v87, 0
    s_nop 1
    v_mfma_f32_16x16x16_bf16 v[84:87], v[46:47], v[70:71], v[84:87]
    s_nop 7
    v_mfma_f32_16x16x32_bf16 v[84:87], v[48:51], v[72:75], v[84:87]
    s_nop 7
    s_nop 1
    v_cvt_pk_bf16_f32 v88, v80, v81
    v_cvt_pk_bf16_f32 v89, v82, v83
    buffer_store_dwordx2 v[88:89], v12, s[8:11], 0 offen offset:160 sc1
    v_cvt_pk_bf16_f32 v90, v84, v85
    v_cvt_pk_bf16_f32 v91, v86, v87
    buffer_store_dwordx2 v[90:91], v13, s[8:11], 0 offen offset:160 sc1
    s_nop 1
    v_mov_b32 v80, 0
    v_mov_b32 v81, 0
    v_mov_b32 v82, 0
    v_mov_b32 v83, 0
    s_nop 1
    v_mfma_f32_16x16x16_bf16 v[80:83], v[52:53], v[64:65], v[80:83]
    s_nop 7
    v_mfma_f32_16x16x32_bf16 v[80:83], v[54:57], v[66:69], v[80:83]
    v_mov_b32 v84, 0
    v_mov_b32 v85, 0
    v_mov_b32 v86, 0
    v_mov_b32 v87, 0
    s_nop 1
    v_mfma_f32_16x16x16_bf16 v[84:87], v[52:53], v[70:71], v[84:87]
    s_nop 7
    v_mfma_f32_16x16x32_bf16 v[84:87], v[54:57], v[72:75], v[84:87]
    s_nop 7
    s_nop 1
    v_cvt_pk_bf16_f32 v88, v80, v81
    v_cvt_pk_bf16_f32 v89, v82, v83
    buffer_store_dwordx2 v[88:89], v12, s[8:11], 0 offen offset:192 sc1
    v_cvt_pk_bf16_f32 v90, v84, v85
    v_cvt_pk_bf16_f32 v91, v86, v87
    buffer_store_dwordx2 v[90:91], v13, s[8:11], 0 offen offset:192 sc1
    s_nop 1
    v_mov_b32 v80, 0
    v_mov_b32 v81, 0
    v_mov_b32 v82, 0
    v_mov_b32 v83, 0
    s_nop 1
    v_mfma_f32_16x16x16_bf16 v[80:83], v[58:59], v[64:65], v[80:83]
    s_nop 7
    v_mfma_f32_16x16x32_bf16 v[80:83], v[60:63], v[66:69], v[80:83]
    v_mov_b32 v84, 0
    v_mov_b32 v85, 0
    v_mov_b32 v86, 0
    v_mov_b32 v87, 0
    s_nop 1
    v_mfma_f32_16x16x16_bf16 v[84:87], v[58:59], v[70:71], v[84:87]
    s_nop 7
    v_mfma_f32_16x16x32_bf16 v[84:87], v[60:63], v[72:75], v[84:87]
    s_nop 7
    s_nop 1
    v_cvt_pk_bf16_f32 v88, v80, v81
    v_cvt_pk_bf16_f32 v89, v82, v83
    buffer_store_dwordx2 v[88:89], v12, s[8:11], 0 offen offset:224 sc1
    v_cvt_pk_bf16_f32 v90, v84, v85
    v_cvt_pk_bf16_f32 v91, v86, v87
    buffer_store_dwordx2 v[90:91], v13, s[8:11], 0 offen offset:224 sc1
    s_nop 1
    s_waitcnt vmcnt(0)
    s_barrier
    s_cmp_lg_u32 s20, 0
    s_cbranch_scc1 .sf93
    v_mov_b32 v4, s46
    v_mov_b32 v5, 1
    s_mov_b64 exec, 1
    buffer_store_dword v5, v4, s[8:11], 0 offen sc1
    s_mov_b64 exec, -1
.sf93:
    s_branch .pn82
.pW79:
    s_and_b32 s22, s20, 3
    s_lshl_b32 s21, s44, 2
    s_add_u32 s21, s21, s22
    s_lshl_b32 s21, s21, 2
    s_add_u32 s21, s21, 0x7104000

    v_mov_b32 v16, s21
    s_mov_b32 s37, 0
.wf94:
    buffer_load_dword v17, v16, s[8:11], 0 offen sc1
    s_waitcnt vmcnt(0)
    v_readfirstlane_b32 s38, v17
    s_add_u32 s37, s37, 1
    s_cmp_lg_u32 s38, 0
    s_cbranch_scc1 .wfd95
    s_sleep 2
    s_cmp_lt_u32 s37, 1048576
    s_cbranch_scc1 .wf94
.wfd95:
    s_barrier
    s_lshl_b32 s21, s44, 5
    s_lshl_b32 s22, s45, 1
    v_add_u32 v4, s21, v2
    s_mov_b32 s23, 8192
    v_mul_lo_u32 v4, v4, s23
    v_lshl_add_u32 v4, v3, 4, v4
    v_add_u32 v4, 0x5000000, v4

    v_add_u32 v8, 0, v4
    v_add_u32 v9, 131072, v4
    s_mul_i32 s25, s22, 131072
    s_add_u32 s25, s25, 0xe00000
    v_lshl_add_u32 v4, v1, 4, s25
    v_add_u32 v12, 0, v4
    v_add_u32 v13, 131072, v4
    s_mul_i32 s26, s20, 1024
    s_mul_i32 s27, s20, 16384
    v_mov_b32 v80, 0
    v_mov_b32 v81, 0
    v_mov_b32 v82, 0
    v_mov_b32 v83, 0
    v_mov_b32 v84, 0
    v_mov_b32 v85, 0
    v_mov_b32 v86, 0
    v_mov_b32 v87, 0
    v_mov_b32 v88, 0
    v_mov_b32 v89, 0
    v_mov_b32 v90, 0
    v_mov_b32 v91, 0
    v_mov_b32 v92, 0
    v_mov_b32 v93, 0
    v_mov_b32 v94, 0
    v_mov_b32 v95, 0
    buffer_load_dwordx4 v[48:51], v12, s[8:11], s27 offen
    buffer_load_dwordx4 v[52:55], v13, s[8:11], s27 offen
    buffer_load_dwordx4 v[16:19], v8, s[8:11], s26 offen sc1
    buffer_load_dwordx4 v[20:23], v9, s[8:11], s26 offen sc1
    s_add_u32 s26, s26, 64
    s_add_u32 s27, s27, 1024
    buffer_load_dwordx4 v[56:59], v12, s[8:11], s27 offen
    buffer_load_dwordx4 v[60:63], v13, s[8:11], s27 offen
    buffer_load_dwordx4 v[24:27], v8, s[8:11], s26 offen sc1
    buffer_load_dwordx4 v[28:31], v9, s[8:11], s26 offen sc1
    s_add_u32 s26, s26, 64
    s_add_u32 s27, s27, 1024
    buffer_load_dwordx4 v[64:67], v12, s[8:11], s27 offen
    buffer_load_dwordx4 v[68:71], v13, s[8:11], s27 offen
    buffer_load_dwordx4 v[32:35], v8, s[8:11], s26 offen sc1
    buffer_load_dwordx4 v[36:39], v9, s[8:11], s26 offen sc1
    s_add_u32 s26, s26, 64
    s_add_u32 s27, s27, 1024
    s_mov_b32 s28, 4
.gl98:
    buffer_load_dwordx4 v[72:75], v12, s[8:11], s27 offen
    buffer_load_dwordx4 v[76:79], v13, s[8:11], s27 offen
    buffer_load_dwordx4 v[40:43], v8, s[8:11], s26 offen sc1
    buffer_load_dwordx4 v[44:47], v9, s[8:11], s26 offen sc1
    s_add_u32 s26, s26, 64
    s_add_u32 s27, s27, 1024
    s_waitcnt vmcnt(12)
    v_mfma_f32_16x16x32_bf16 v[80:83], v[48:51], v[16:19], v[80:83]
    v_mfma_f32_16x16x32_bf16 v[84:87], v[48:51], v[20:23], v[84:87]
    v_mfma_f32_16x16x32_bf16 v[88:91], v[52:55], v[16:19], v[88:91]
    v_mfma_f32_16x16x32_bf16 v[92:95], v[52:55], v[20:23], v[92:95]
    buffer_load_dwordx4 v[48:51], v12, s[8:11], s27 offen
    buffer_load_dwordx4 v[52:55], v13, s[8:11], s27 offen
    buffer_load_dwordx4 v[16:19], v8, s[8:11], s26 offen sc1
    buffer_load_dwordx4 v[20:23], v9, s[8:11], s26 offen sc1
    s_add_u32 s26, s26, 64
    s_add_u32 s27, s27, 1024
    s_waitcnt vmcnt(12)
    v_mfma_f32_16x16x32_bf16 v[80:83], v[56:59], v[24:27], v[80:83]
    v_mfma_f32_16x16x32_bf16 v[84:87], v[56:59], v[28:31], v[84:87]
    v_mfma_f32_16x16x32_bf16 v[88:91], v[60:63], v[24:27], v[88:91]
    v_mfma_f32_16x16x32_bf16 v[92:95], v[60:63], v[28:31], v[92:95]
    buffer_load_dwordx4 v[56:59], v12, s[8:11], s27 offen
    buffer_load_dwordx4 v[60:63], v13, s[8:11], s27 offen
    buffer_load_dwordx4 v[24:27], v8, s[8:11], s26 offen sc1
    buffer_load_dwordx4 v[28:31], v9, s[8:11], s26 offen sc1
    s_add_u32 s26, s26, 64
    s_add_u32 s27, s27, 1024
    s_waitcnt vmcnt(12)
    v_mfma_f32_16x16x32_bf16 v[80:83], v[64:67], v[32:35], v[80:83]
    v_mfma_f32_16x16x32_bf16 v[84:87], v[64:67], v[36:39], v[84:87]
    v_mfma_f32_16x16x32_bf16 v[88:91], v[68:71], v[32:35], v[88:91]
    v_mfma_f32_16x16x32_bf16 v[92:95], v[68:71], v[36:39], v[92:95]
    buffer_load_dwordx4 v[64:67], v12, s[8:11], s27 offen
    buffer_load_dwordx4 v[68:71], v13, s[8:11], s27 offen
    buffer_load_dwordx4 v[32:35], v8, s[8:11], s26 offen sc1
    buffer_load_dwordx4 v[36:39], v9, s[8:11], s26 offen sc1
    s_add_u32 s26, s26, 64
    s_add_u32 s27, s27, 1024
    s_waitcnt vmcnt(12)
    v_mfma_f32_16x16x32_bf16 v[80:83], v[72:75], v[40:43], v[80:83]
    v_mfma_f32_16x16x32_bf16 v[84:87], v[72:75], v[44:47], v[84:87]
    v_mfma_f32_16x16x32_bf16 v[88:91], v[76:79], v[40:43], v[88:91]
    v_mfma_f32_16x16x32_bf16 v[92:95], v[76:79], v[44:47], v[92:95]
    s_sub_u32 s28, s28, 1
    s_cmp_lg_u32 s28, 0
    s_cbranch_scc1 .gl98
    s_waitcnt vmcnt(0) lgkmcnt(0)
    s_nop 7
    s_nop 7
    s_lshl_b32 s25, s20, 12
    v_lshl_add_u32 v4, v1, 4, s25
    ds_write_b128 v4, v[80:83] offset:0
    ds_write_b128 v4, v[84:87] offset:1024
    ds_write_b128 v4, v[88:91] offset:2048
    ds_write_b128 v4, v[92:95] offset:3072
    s_waitcnt lgkmcnt(0)
    s_barrier
    s_cmp_ge_u32 s20, 4
    s_cbranch_scc1 .sks99
    s_lshl_b32 s25, s20, 10
    v_lshl_add_u32 v4, v1, 4, s25
    ds_read_b128 v[16:19], v4 offset:0
    ds_read_b128 v[20:23], v4 offset:4096
    ds_read_b128 v[24:27], v4 offset:8192
    ds_read_b128 v[28:31], v4 offset:12288
    ds_read_b128 v[32:35], v4 offset:16384
    ds_read_b128 v[36:39], v4 offset:20480
    ds_read_b128 v[40:43], v4 offset:24576
    ds_read_b128 v[44:47], v4 offset:28672
    s_and_b32 s25, s20, 1
    s_lshl_b32 s25, s25, 4
    s_add_u32 s25, s25, s21
    v_add_u32 v5, s25, v2
    v_lshlrev_b32 v5, 10, v5
    s_lshr_b32 s25, s20, 1
    s_add_u32 s25, s25, s22
    s_lshl_b32 s25, s25, 5
    v_lshl_add_u32 v5, v3, 3, v5
    v_add_u32 v5, s25, v5
    v_add_u32 v6, 0x6000000, v5

    buffer_load_dwordx2 v[96:97], v5, s[12:15], 0 offen
    s_waitcnt vmcnt(0) lgkmcnt(0)
    v_add_f32 v16, v16, v20
    v_add_f32 v16, v16, v24
    v_add_f32 v16, v16, v28
    v_add_f32 v16, v16, v32
    v_add_f32 v16, v16, v36
    v_add_f32 v16, v16, v40
    v_add_f32 v16, v16, v44
    v_add_f32 v17, v17, v21
    v_add_f32 v17, v17, v25
    v_add_f32 v17, v17, v29
    v_add_f32 v17, v17, v33
    v_add_f32 v17, v17, v37
    v_add_f32 v17, v17, v41
    v_add_f32 v17, v17, v45
    v_add_f32 v18, v18, v22
    v_add_f32 v18, v18, v26
    v_add_f32 v18, v18, v30
    v_add_f32 v18, v18, v34
    v_add_f32 v18, v18, v38
    v_add_f32 v18, v18, v42
    v_add_f32 v18, v18, v46
    v_add_f32 v19, v19, v23
    v_add_f32 v19, v19, v27
    v_add_f32 v19, v19, v31
    v_add_f32 v19, v19, v35
    v_add_f32 v19, v19, v39
    v_add_f32 v19, v19, v43
    v_add_f32 v19, v19, v47
    v_cvt_pk_bf16_f32 v90, v16, v17
    v_cvt_pk_bf16_f32 v91, v18, v19
    v_lshlrev_b32 v92, 16, v90
    v_and_b32 v93, 0xffff0000, v90
    v_lshlrev_b32 v94, 16, v96
    v_and_b32 v95, 0xffff0000, v96
    v_add_f32 v92, v92, v94
    v_add_f32 v93, v93, v95
    v_cvt_pk_bf16_f32 v100, v92, v93
    v_lshlrev_b32 v92, 16, v91
    v_and_b32 v93, 0xffff0000, v91
    v_lshlrev_b32 v94, 16, v97
    v_and_b32 v95, 0xffff0000, v97
    v_add_f32 v92, v92, v94
    v_add_f32 v93, v93, v95
    v_cvt_pk_bf16_f32 v101, v92, v93
    buffer_store_dwordx2 v[100:101], v6, s[8:11], 0 offen sc1
.sks99:
    s_lshl_b32 s46, s44, 4
    s_add_u32 s46, s46, s45
    s_lshl_b32 s46, s46, 2
    s_add_u32 s46, s46, 0x7104400
    s_waitcnt vmcnt(0)
    s_barrier
    s_cmp_lg_u32 s20, 0
    s_cbranch_scc1 .sf100
    v_mov_b32 v4, s46
    v_mov_b32 v5, 1
    s_mov_b64 exec, 1
    buffer_store_dword v5, v4, s[8:11], 0 offen sc1
    s_mov_b64 exec, -1
.sf100:
    s_branch .pn82
.pF180:
    s_lshl_b32 s21, s44, 4
    s_add_u32 s21, s21, s20
    s_lshl_b32 s21, s21, 2
    s_add_u32 s21, s21, 0x7104400

    v_mov_b32 v16, s21
    s_mov_b32 s37, 0
.wf101:
    buffer_load_dword v17, v16, s[8:11], 0 offen sc1
    s_waitcnt vmcnt(0)
    v_readfirstlane_b32 s38, v17
    s_add_u32 s37, s37, 1
    s_cmp_lg_u32 s38, 0
    s_cbranch_scc1 .wfd102
    s_sleep 2
    s_cmp_lt_u32 s37, 1048576
    s_cbranch_scc1 .wf101
.wfd102:
    s_add_u32 s21, s21, 32
    v_mov_b32 v16, s21
    s_mov_b32 s37, 0
.wf103:
    buffer_load_dword v17, v16, s[8:11], 0 offen sc1
    s_waitcnt vmcnt(0)
    v_readfirstlane_b32 s38, v17
    s_add_u32 s37, s37, 1
    s_cmp_lg_u32 s38, 0
    s_cbranch_scc1 .wfd104
    s_sleep 2
    s_cmp_lt_u32 s37, 1048576
    s_cbranch_scc1 .wf103
.wfd104:
    s_barrier
    s_lshl_b32 s21, s44, 5
    s_lshl_b32 s22, s20, 2
    s_add_u32 s21, s21, s22
    s_add_u32 s21, s21, 0
    v_mov_b32 v4, s21
    s_lshl_b32 s22, s20, 2
    s_add_u32 s22, s22, 0
    s_mul_i32 s22, s22, 1040
    v_lshl_add_u32 v40, v1, 4, s22
    v_lshlrev_b32 v2, 10, v4
    v_lshl_add_u32 v2, v1, 4, v2
    v_add_u32 v3, 0x6000000, v2
    buffer_load_dwordx4 v[8:11], v3, s[8:11], 0 offen sc1
    s_waitcnt vmcnt(0)

    v_lshlrev_b32 v12, 16, v8
    v_and_b32 v13, 0xffff0000, v8
    v_lshlrev_b32 v14, 16, v9
    v_and_b32 v15, 0xffff0000, v9
    v_lshlrev_b32 v16, 16, v10
    v_and_b32 v17, 0xffff0000, v10
    v_lshlrev_b32 v18, 16, v11
    v_and_b32 v19, 0xffff0000, v11
    v_add_f32 v20, v12, v13
    v_add_f32 v20, v20, v14
    v_add_f32 v20, v20, v15
    v_add_f32 v20, v20, v16
    v_add_f32 v20, v20, v17
    v_add_f32 v20, v20, v18
    v_add_f32 v20, v20, v19
    s_nop 1
    v_add_f32_dpp v21, v20, v20 row_ror:8 row_mask:0xf bank_mask:0xf
    s_nop 1
    v_mov_b32 v20, v21
    s_nop 1
    v_add_f32_dpp v21, v20, v20 row_ror:4 row_mask:0xf bank_mask:0xf
    s_nop 1
    v_mov_b32 v20, v21
    s_nop 1
    v_add_f32_dpp v21, v20, v20 row_ror:2 row_mask:0xf bank_mask:0xf
    s_nop 1
    v_mov_b32 v20, v21
    s_nop 1
    v_add_f32_dpp v21, v20, v20 row_ror:1 row_mask:0xf bank_mask:0xf
    s_nop 1
    v_mov_b32 v20, v21
    v_mov_b32 v21, v20
    s_nop 1
    v_permlane16_swap_b32 v20, v21
    s_nop 1
    v_add_f32 v20, v20, v21
    v_mov_b32 v21, v20
    s_nop 1
    v_permlane32_swap_b32 v20, v21
    s_nop 1
    v_add_f32 v20, v20, v21
    v_mul_f32 v20, 0x3b000000, v20
    v_sub_f32 v22, v12, v20
    v_sub_f32 v23, v13, v20
    v_sub_f32 v24, v14, v20
    v_sub_f32 v25, v15, v20
    v_sub_f32 v26, v16, v20
    v_sub_f32 v27, v17, v20
    v_sub_f32 v28, v18, v20
    v_sub_f32 v29, v19, v20
    v_mul_f32 v30, v22, v22
    v_fmac_f32 v30, v23, v23
    v_fmac_f32 v30, v24, v24
    v_fmac_f32 v30, v25, v25
    v_fmac_f32 v30, v26, v26
    v_fmac_f32 v30, v27, v27
    v_fmac_f32 v30, v28, v28
    v_fmac_f32 v30, v29, v29
    s_nop 1
    v_add_f32_dpp v21, v30, v30 row_ror:8 row_mask:0xf bank_mask:0xf
    s_nop 1
    v_mov_b32 v30, v21
    s_nop 1
    v_add_f32_dpp v21, v30, v30 row_ror:4 row_mask:0xf bank_mask:0xf
    s_nop 1
    v_mov_b32 v30, v21
    s_nop 1
    v_add_f32_dpp v21, v30, v30 row_ror:2 row_mask:0xf bank_mask:0xf
    s_nop 1
    v_mov_b32 v30, v21
    s_nop 1
    v_add_f32_dpp v21, v30, v30 row_ror:1 row_mask:0xf bank_mask:0xf
    s_nop 1
    v_mov_b32 v30, v21
    v_mov_b32 v21, v30
    s_nop 1
    v_permlane16_swap_b32 v30, v21
    s_nop 1
    v_add_f32 v30, v30, v21
    v_mov_b32 v21, v30
    s_nop 1
    v_permlane32_swap_b32 v30, v21
    s_nop 1
    v_add_f32 v30, v30, v21
    v_mul_f32 v30, 0x3b000000, v30
    v_cvt_pk_bf16_f32 v31, v20, v30
    v_lshlrev_b32 v20, 16, v31
    v_and_b32 v30, 0xffff0000, v31
    v_add_f32 v30, 0x3727c5ac, v30
    v_cvt_pk_bf16_f32 v31, v30, v30
    v_and_b32 v30, 0xffff0000, v31
    v_sqrt_f32 v30, v30
    s_nop 0
    v_cvt_pk_bf16_f32 v31, v30, v30
    v_and_b32 v30, 0xffff0000, v31
    v_rcp_f32 v30, v30
    s_nop 0
    v_sub_f32 v22, v12, v20
    v_sub_f32 v23, v13, v20
    v_sub_f32 v24, v14, v20
    v_sub_f32 v25, v15, v20
    v_sub_f32 v26, v16, v20
    v_sub_f32 v27, v17, v20
    v_sub_f32 v28, v18, v20
    v_sub_f32 v29, v19, v20
    v_cvt_pk_bf16_f32 v8, v22, v23
    v_cvt_pk_bf16_f32 v9, v24, v25
    v_cvt_pk_bf16_f32 v10, v26, v27
    v_cvt_pk_bf16_f32 v11, v28, v29
    v_lshlrev_b32 v12, 16, v8
    v_and_b32 v13, 0xffff0000, v8
    v_lshlrev_b32 v14, 16, v9
    v_and_b32 v15, 0xffff0000, v9
    v_lshlrev_b32 v16, 16, v10
    v_and_b32 v17, 0xffff0000, v10
    v_lshlrev_b32 v18, 16, v11
    v_and_b32 v19, 0xffff0000, v11
    v_mul_f32 v12, v12, v30
    v_mul_f32 v13, v13, v30
    v_mul_f32 v14, v14, v30
    v_mul_f32 v15, v15, v30
    v_mul_f32 v16, v16, v30
    v_mul_f32 v17, v17, v30
    v_mul_f32 v18, v18, v30
    v_mul_f32 v19, v19, v30
    v_cvt_pk_bf16_f32 v8, v12, v13
    v_cvt_pk_bf16_f32 v9, v14, v15
    v_cvt_pk_bf16_f32 v10, v16, v17
    v_cvt_pk_bf16_f32 v11, v18, v19
    ds_write_b128 v40, v[8:11]
    s_lshl_b32 s21, s44, 5
    s_lshl_b32 s22, s20, 2
    s_add_u32 s21, s21, s22
    s_add_u32 s21, s21, 1
    v_mov_b32 v4, s21
    s_lshl_b32 s22, s20, 2
    s_add_u32 s22, s22, 1
    s_mul_i32 s22, s22, 1040
    v_lshl_add_u32 v40, v1, 4, s22
    v_lshlrev_b32 v2, 10, v4
    v_lshl_add_u32 v2, v1, 4, v2
    v_add_u32 v3, 0x6000000, v2
    buffer_load_dwordx4 v[8:11], v3, s[8:11], 0 offen sc1
    s_waitcnt vmcnt(0)

    v_lshlrev_b32 v12, 16, v8
    v_and_b32 v13, 0xffff0000, v8
    v_lshlrev_b32 v14, 16, v9
    v_and_b32 v15, 0xffff0000, v9
    v_lshlrev_b32 v16, 16, v10
    v_and_b32 v17, 0xffff0000, v10
    v_lshlrev_b32 v18, 16, v11
    v_and_b32 v19, 0xffff0000, v11
    v_add_f32 v20, v12, v13
    v_add_f32 v20, v20, v14
    v_add_f32 v20, v20, v15
    v_add_f32 v20, v20, v16
    v_add_f32 v20, v20, v17
    v_add_f32 v20, v20, v18
    v_add_f32 v20, v20, v19
    s_nop 1
    v_add_f32_dpp v21, v20, v20 row_ror:8 row_mask:0xf bank_mask:0xf
    s_nop 1
    v_mov_b32 v20, v21
    s_nop 1
    v_add_f32_dpp v21, v20, v20 row_ror:4 row_mask:0xf bank_mask:0xf
    s_nop 1
    v_mov_b32 v20, v21
    s_nop 1
    v_add_f32_dpp v21, v20, v20 row_ror:2 row_mask:0xf bank_mask:0xf
    s_nop 1
    v_mov_b32 v20, v21
    s_nop 1
    v_add_f32_dpp v21, v20, v20 row_ror:1 row_mask:0xf bank_mask:0xf
    s_nop 1
    v_mov_b32 v20, v21
    v_mov_b32 v21, v20
    s_nop 1
    v_permlane16_swap_b32 v20, v21
    s_nop 1
    v_add_f32 v20, v20, v21
    v_mov_b32 v21, v20
    s_nop 1
    v_permlane32_swap_b32 v20, v21
    s_nop 1
    v_add_f32 v20, v20, v21
    v_mul_f32 v20, 0x3b000000, v20
    v_sub_f32 v22, v12, v20
    v_sub_f32 v23, v13, v20
    v_sub_f32 v24, v14, v20
    v_sub_f32 v25, v15, v20
    v_sub_f32 v26, v16, v20
    v_sub_f32 v27, v17, v20
    v_sub_f32 v28, v18, v20
    v_sub_f32 v29, v19, v20
    v_mul_f32 v30, v22, v22
    v_fmac_f32 v30, v23, v23
    v_fmac_f32 v30, v24, v24
    v_fmac_f32 v30, v25, v25
    v_fmac_f32 v30, v26, v26
    v_fmac_f32 v30, v27, v27
    v_fmac_f32 v30, v28, v28
    v_fmac_f32 v30, v29, v29
    s_nop 1
    v_add_f32_dpp v21, v30, v30 row_ror:8 row_mask:0xf bank_mask:0xf
    s_nop 1
    v_mov_b32 v30, v21
    s_nop 1
    v_add_f32_dpp v21, v30, v30 row_ror:4 row_mask:0xf bank_mask:0xf
    s_nop 1
    v_mov_b32 v30, v21
    s_nop 1
    v_add_f32_dpp v21, v30, v30 row_ror:2 row_mask:0xf bank_mask:0xf
    s_nop 1
    v_mov_b32 v30, v21
    s_nop 1
    v_add_f32_dpp v21, v30, v30 row_ror:1 row_mask:0xf bank_mask:0xf
    s_nop 1
    v_mov_b32 v30, v21
    v_mov_b32 v21, v30
    s_nop 1
    v_permlane16_swap_b32 v30, v21
    s_nop 1
    v_add_f32 v30, v30, v21
    v_mov_b32 v21, v30
    s_nop 1
    v_permlane32_swap_b32 v30, v21
    s_nop 1
    v_add_f32 v30, v30, v21
    v_mul_f32 v30, 0x3b000000, v30
    v_cvt_pk_bf16_f32 v31, v20, v30
    v_lshlrev_b32 v20, 16, v31
    v_and_b32 v30, 0xffff0000, v31
    v_add_f32 v30, 0x3727c5ac, v30
    v_cvt_pk_bf16_f32 v31, v30, v30
    v_and_b32 v30, 0xffff0000, v31
    v_sqrt_f32 v30, v30
    s_nop 0
    v_cvt_pk_bf16_f32 v31, v30, v30
    v_and_b32 v30, 0xffff0000, v31
    v_rcp_f32 v30, v30
    s_nop 0
    v_sub_f32 v22, v12, v20
    v_sub_f32 v23, v13, v20
    v_sub_f32 v24, v14, v20
    v_sub_f32 v25, v15, v20
    v_sub_f32 v26, v16, v20
    v_sub_f32 v27, v17, v20
    v_sub_f32 v28, v18, v20
    v_sub_f32 v29, v19, v20
    v_cvt_pk_bf16_f32 v8, v22, v23
    v_cvt_pk_bf16_f32 v9, v24, v25
    v_cvt_pk_bf16_f32 v10, v26, v27
    v_cvt_pk_bf16_f32 v11, v28, v29
    v_lshlrev_b32 v12, 16, v8
    v_and_b32 v13, 0xffff0000, v8
    v_lshlrev_b32 v14, 16, v9
    v_and_b32 v15, 0xffff0000, v9
    v_lshlrev_b32 v16, 16, v10
    v_and_b32 v17, 0xffff0000, v10
    v_lshlrev_b32 v18, 16, v11
    v_and_b32 v19, 0xffff0000, v11
    v_mul_f32 v12, v12, v30
    v_mul_f32 v13, v13, v30
    v_mul_f32 v14, v14, v30
    v_mul_f32 v15, v15, v30
    v_mul_f32 v16, v16, v30
    v_mul_f32 v17, v17, v30
    v_mul_f32 v18, v18, v30
    v_mul_f32 v19, v19, v30
    v_cvt_pk_bf16_f32 v8, v12, v13
    v_cvt_pk_bf16_f32 v9, v14, v15
    v_cvt_pk_bf16_f32 v10, v16, v17
    v_cvt_pk_bf16_f32 v11, v18, v19
    ds_write_b128 v40, v[8:11]
    s_lshl_b32 s21, s44, 5
    s_lshl_b32 s22, s20, 2
    s_add_u32 s21, s21, s22
    s_add_u32 s21, s21, 2
    v_mov_b32 v4, s21
    s_lshl_b32 s22, s20, 2
    s_add_u32 s22, s22, 2
    s_mul_i32 s22, s22, 1040
    v_lshl_add_u32 v40, v1, 4, s22
    v_lshlrev_b32 v2, 10, v4
    v_lshl_add_u32 v2, v1, 4, v2
    v_add_u32 v3, 0x6000000, v2
    buffer_load_dwordx4 v[8:11], v3, s[8:11], 0 offen sc1
    s_waitcnt vmcnt(0)

    v_lshlrev_b32 v12, 16, v8
    v_and_b32 v13, 0xffff0000, v8
    v_lshlrev_b32 v14, 16, v9
    v_and_b32 v15, 0xffff0000, v9
    v_lshlrev_b32 v16, 16, v10
    v_and_b32 v17, 0xffff0000, v10
    v_lshlrev_b32 v18, 16, v11
    v_and_b32 v19, 0xffff0000, v11
    v_add_f32 v20, v12, v13
    v_add_f32 v20, v20, v14
    v_add_f32 v20, v20, v15
    v_add_f32 v20, v20, v16
    v_add_f32 v20, v20, v17
    v_add_f32 v20, v20, v18
    v_add_f32 v20, v20, v19
    s_nop 1
    v_add_f32_dpp v21, v20, v20 row_ror:8 row_mask:0xf bank_mask:0xf
    s_nop 1
    v_mov_b32 v20, v21
    s_nop 1
    v_add_f32_dpp v21, v20, v20 row_ror:4 row_mask:0xf bank_mask:0xf
    s_nop 1
    v_mov_b32 v20, v21
    s_nop 1
    v_add_f32_dpp v21, v20, v20 row_ror:2 row_mask:0xf bank_mask:0xf
    s_nop 1
    v_mov_b32 v20, v21
    s_nop 1
    v_add_f32_dpp v21, v20, v20 row_ror:1 row_mask:0xf bank_mask:0xf
    s_nop 1
    v_mov_b32 v20, v21
    v_mov_b32 v21, v20
    s_nop 1
    v_permlane16_swap_b32 v20, v21
    s_nop 1
    v_add_f32 v20, v20, v21
    v_mov_b32 v21, v20
    s_nop 1
    v_permlane32_swap_b32 v20, v21
    s_nop 1
    v_add_f32 v20, v20, v21
    v_mul_f32 v20, 0x3b000000, v20
    v_sub_f32 v22, v12, v20
    v_sub_f32 v23, v13, v20
    v_sub_f32 v24, v14, v20
    v_sub_f32 v25, v15, v20
    v_sub_f32 v26, v16, v20
    v_sub_f32 v27, v17, v20
    v_sub_f32 v28, v18, v20
    v_sub_f32 v29, v19, v20
    v_mul_f32 v30, v22, v22
    v_fmac_f32 v30, v23, v23
    v_fmac_f32 v30, v24, v24
    v_fmac_f32 v30, v25, v25
    v_fmac_f32 v30, v26, v26
    v_fmac_f32 v30, v27, v27
    v_fmac_f32 v30, v28, v28
    v_fmac_f32 v30, v29, v29
    s_nop 1
    v_add_f32_dpp v21, v30, v30 row_ror:8 row_mask:0xf bank_mask:0xf
    s_nop 1
    v_mov_b32 v30, v21
    s_nop 1
    v_add_f32_dpp v21, v30, v30 row_ror:4 row_mask:0xf bank_mask:0xf
    s_nop 1
    v_mov_b32 v30, v21
    s_nop 1
    v_add_f32_dpp v21, v30, v30 row_ror:2 row_mask:0xf bank_mask:0xf
    s_nop 1
    v_mov_b32 v30, v21
    s_nop 1
    v_add_f32_dpp v21, v30, v30 row_ror:1 row_mask:0xf bank_mask:0xf
    s_nop 1
    v_mov_b32 v30, v21
    v_mov_b32 v21, v30
    s_nop 1
    v_permlane16_swap_b32 v30, v21
    s_nop 1
    v_add_f32 v30, v30, v21
    v_mov_b32 v21, v30
    s_nop 1
    v_permlane32_swap_b32 v30, v21
    s_nop 1
    v_add_f32 v30, v30, v21
    v_mul_f32 v30, 0x3b000000, v30
    v_cvt_pk_bf16_f32 v31, v20, v30
    v_lshlrev_b32 v20, 16, v31
    v_and_b32 v30, 0xffff0000, v31
    v_add_f32 v30, 0x3727c5ac, v30
    v_cvt_pk_bf16_f32 v31, v30, v30
    v_and_b32 v30, 0xffff0000, v31
    v_sqrt_f32 v30, v30
    s_nop 0
    v_cvt_pk_bf16_f32 v31, v30, v30
    v_and_b32 v30, 0xffff0000, v31
    v_rcp_f32 v30, v30
    s_nop 0
    v_sub_f32 v22, v12, v20
    v_sub_f32 v23, v13, v20
    v_sub_f32 v24, v14, v20
    v_sub_f32 v25, v15, v20
    v_sub_f32 v26, v16, v20
    v_sub_f32 v27, v17, v20
    v_sub_f32 v28, v18, v20
    v_sub_f32 v29, v19, v20
    v_cvt_pk_bf16_f32 v8, v22, v23
    v_cvt_pk_bf16_f32 v9, v24, v25
    v_cvt_pk_bf16_f32 v10, v26, v27
    v_cvt_pk_bf16_f32 v11, v28, v29
    v_lshlrev_b32 v12, 16, v8
    v_and_b32 v13, 0xffff0000, v8
    v_lshlrev_b32 v14, 16, v9
    v_and_b32 v15, 0xffff0000, v9
    v_lshlrev_b32 v16, 16, v10
    v_and_b32 v17, 0xffff0000, v10
    v_lshlrev_b32 v18, 16, v11
    v_and_b32 v19, 0xffff0000, v11
    v_mul_f32 v12, v12, v30
    v_mul_f32 v13, v13, v30
    v_mul_f32 v14, v14, v30
    v_mul_f32 v15, v15, v30
    v_mul_f32 v16, v16, v30
    v_mul_f32 v17, v17, v30
    v_mul_f32 v18, v18, v30
    v_mul_f32 v19, v19, v30
    v_cvt_pk_bf16_f32 v8, v12, v13
    v_cvt_pk_bf16_f32 v9, v14, v15
    v_cvt_pk_bf16_f32 v10, v16, v17
    v_cvt_pk_bf16_f32 v11, v18, v19
    ds_write_b128 v40, v[8:11]
    s_lshl_b32 s21, s44, 5
    s_lshl_b32 s22, s20, 2
    s_add_u32 s21, s21, s22
    s_add_u32 s21, s21, 3
    v_mov_b32 v4, s21
    s_lshl_b32 s22, s20, 2
    s_add_u32 s22, s22, 3
    s_mul_i32 s22, s22, 1040
    v_lshl_add_u32 v40, v1, 4, s22
    v_lshlrev_b32 v2, 10, v4
    v_lshl_add_u32 v2, v1, 4, v2
    v_add_u32 v3, 0x6000000, v2
    buffer_load_dwordx4 v[8:11], v3, s[8:11], 0 offen sc1
    s_waitcnt vmcnt(0)

    v_lshlrev_b32 v12, 16, v8
    v_and_b32 v13, 0xffff0000, v8
    v_lshlrev_b32 v14, 16, v9
    v_and_b32 v15, 0xffff0000, v9
    v_lshlrev_b32 v16, 16, v10
    v_and_b32 v17, 0xffff0000, v10
    v_lshlrev_b32 v18, 16, v11
    v_and_b32 v19, 0xffff0000, v11
    v_add_f32 v20, v12, v13
    v_add_f32 v20, v20, v14
    v_add_f32 v20, v20, v15
    v_add_f32 v20, v20, v16
    v_add_f32 v20, v20, v17
    v_add_f32 v20, v20, v18
    v_add_f32 v20, v20, v19
    s_nop 1
    v_add_f32_dpp v21, v20, v20 row_ror:8 row_mask:0xf bank_mask:0xf
    s_nop 1
    v_mov_b32 v20, v21
    s_nop 1
    v_add_f32_dpp v21, v20, v20 row_ror:4 row_mask:0xf bank_mask:0xf
    s_nop 1
    v_mov_b32 v20, v21
    s_nop 1
    v_add_f32_dpp v21, v20, v20 row_ror:2 row_mask:0xf bank_mask:0xf
    s_nop 1
    v_mov_b32 v20, v21
    s_nop 1
    v_add_f32_dpp v21, v20, v20 row_ror:1 row_mask:0xf bank_mask:0xf
    s_nop 1
    v_mov_b32 v20, v21
    v_mov_b32 v21, v20
    s_nop 1
    v_permlane16_swap_b32 v20, v21
    s_nop 1
    v_add_f32 v20, v20, v21
    v_mov_b32 v21, v20
    s_nop 1
    v_permlane32_swap_b32 v20, v21
    s_nop 1
    v_add_f32 v20, v20, v21
    v_mul_f32 v20, 0x3b000000, v20
    v_sub_f32 v22, v12, v20
    v_sub_f32 v23, v13, v20
    v_sub_f32 v24, v14, v20
    v_sub_f32 v25, v15, v20
    v_sub_f32 v26, v16, v20
    v_sub_f32 v27, v17, v20
    v_sub_f32 v28, v18, v20
    v_sub_f32 v29, v19, v20
    v_mul_f32 v30, v22, v22
    v_fmac_f32 v30, v23, v23
    v_fmac_f32 v30, v24, v24
    v_fmac_f32 v30, v25, v25
    v_fmac_f32 v30, v26, v26
    v_fmac_f32 v30, v27, v27
    v_fmac_f32 v30, v28, v28
    v_fmac_f32 v30, v29, v29
    s_nop 1
    v_add_f32_dpp v21, v30, v30 row_ror:8 row_mask:0xf bank_mask:0xf
    s_nop 1
    v_mov_b32 v30, v21
    s_nop 1
    v_add_f32_dpp v21, v30, v30 row_ror:4 row_mask:0xf bank_mask:0xf
    s_nop 1
    v_mov_b32 v30, v21
    s_nop 1
    v_add_f32_dpp v21, v30, v30 row_ror:2 row_mask:0xf bank_mask:0xf
    s_nop 1
    v_mov_b32 v30, v21
    s_nop 1
    v_add_f32_dpp v21, v30, v30 row_ror:1 row_mask:0xf bank_mask:0xf
    s_nop 1
    v_mov_b32 v30, v21
    v_mov_b32 v21, v30
    s_nop 1
    v_permlane16_swap_b32 v30, v21
    s_nop 1
    v_add_f32 v30, v30, v21
    v_mov_b32 v21, v30
    s_nop 1
    v_permlane32_swap_b32 v30, v21
    s_nop 1
    v_add_f32 v30, v30, v21
    v_mul_f32 v30, 0x3b000000, v30
    v_cvt_pk_bf16_f32 v31, v20, v30
    v_lshlrev_b32 v20, 16, v31
    v_and_b32 v30, 0xffff0000, v31
    v_add_f32 v30, 0x3727c5ac, v30
    v_cvt_pk_bf16_f32 v31, v30, v30
    v_and_b32 v30, 0xffff0000, v31
    v_sqrt_f32 v30, v30
    s_nop 0
    v_cvt_pk_bf16_f32 v31, v30, v30
    v_and_b32 v30, 0xffff0000, v31
    v_rcp_f32 v30, v30
    s_nop 0
    v_sub_f32 v22, v12, v20
    v_sub_f32 v23, v13, v20
    v_sub_f32 v24, v14, v20
    v_sub_f32 v25, v15, v20
    v_sub_f32 v26, v16, v20
    v_sub_f32 v27, v17, v20
    v_sub_f32 v28, v18, v20
    v_sub_f32 v29, v19, v20
    v_cvt_pk_bf16_f32 v8, v22, v23
    v_cvt_pk_bf16_f32 v9, v24, v25
    v_cvt_pk_bf16_f32 v10, v26, v27
    v_cvt_pk_bf16_f32 v11, v28, v29
    v_lshlrev_b32 v12, 16, v8
    v_and_b32 v13, 0xffff0000, v8
    v_lshlrev_b32 v14, 16, v9
    v_and_b32 v15, 0xffff0000, v9
    v_lshlrev_b32 v16, 16, v10
    v_and_b32 v17, 0xffff0000, v10
    v_lshlrev_b32 v18, 16, v11
    v_and_b32 v19, 0xffff0000, v11
    v_mul_f32 v12, v12, v30
    v_mul_f32 v13, v13, v30
    v_mul_f32 v14, v14, v30
    v_mul_f32 v15, v15, v30
    v_mul_f32 v16, v16, v30
    v_mul_f32 v17, v17, v30
    v_mul_f32 v18, v18, v30
    v_mul_f32 v19, v19, v30
    v_cvt_pk_bf16_f32 v8, v12, v13
    v_cvt_pk_bf16_f32 v9, v14, v15
    v_cvt_pk_bf16_f32 v10, v16, v17
    v_cvt_pk_bf16_f32 v11, v18, v19
    ds_write_b128 v40, v[8:11]
    v_and_b32 v2, 15, v1
    v_lshrrev_b32 v3, 4, v1
    s_waitcnt lgkmcnt(0)
    s_barrier
    s_lshl_b32 s22, s45, 3
    s_add_u32 s22, s22, s20
    s_mov_b32 s23, 1040
    v_mul_lo_u32 v4, v2, s23
    v_lshl_add_u32 v4, v3, 4, v4

    v_add_u32 v8, 0, v4
    v_add_u32 v9, 16640, v4
    s_lshl_b32 s25, s22, 14
    v_lshl_add_u32 v4, v1, 4, s25
    v_add_u32 v12, 0x1200000, v4
    v_add_u32 v13, 0x1400000, v4
    s_mov_b32 s26, 0
    s_mov_b32 s27, 0
    v_mov_b32 v80, 0
    v_mov_b32 v81, 0
    v_mov_b32 v82, 0
    v_mov_b32 v83, 0
    v_mov_b32 v84, 0
    v_mov_b32 v85, 0
    v_mov_b32 v86, 0
    v_mov_b32 v87, 0
    v_mov_b32 v88, 0
    v_mov_b32 v89, 0
    v_mov_b32 v90, 0
    v_mov_b32 v91, 0
    v_mov_b32 v92, 0
    v_mov_b32 v93, 0
    v_mov_b32 v94, 0
    v_mov_b32 v95, 0
    buffer_load_dwordx4 v[48:51], v12, s[8:11], s27 offen
    buffer_load_dwordx4 v[52:55], v13, s[8:11], s27 offen
    ds_read_b128 v[16:19], v8
    v_add_u32 v8, 64, v8
    ds_read_b128 v[20:23], v9
    v_add_u32 v9, 64, v9
    s_add_u32 s26, s26, 64
    s_add_u32 s27, s27, 1024
    buffer_load_dwordx4 v[56:59], v12, s[8:11], s27 offen
    buffer_load_dwordx4 v[60:63], v13, s[8:11], s27 offen
    ds_read_b128 v[24:27], v8
    v_add_u32 v8, 64, v8
    ds_read_b128 v[28:31], v9
    v_add_u32 v9, 64, v9
    s_add_u32 s26, s26, 64
    s_add_u32 s27, s27, 1024
    buffer_load_dwordx4 v[64:67], v12, s[8:11], s27 offen
    buffer_load_dwordx4 v[68:71], v13, s[8:11], s27 offen
    ds_read_b128 v[32:35], v8
    v_add_u32 v8, 64, v8
    ds_read_b128 v[36:39], v9
    v_add_u32 v9, 64, v9
    s_add_u32 s26, s26, 64
    s_add_u32 s27, s27, 1024
    s_mov_b32 s28, 4
.gl105:
    buffer_load_dwordx4 v[72:75], v12, s[8:11], s27 offen
    buffer_load_dwordx4 v[76:79], v13, s[8:11], s27 offen
    ds_read_b128 v[40:43], v8
    v_add_u32 v8, 64, v8
    ds_read_b128 v[44:47], v9
    v_add_u32 v9, 64, v9
    s_add_u32 s26, s26, 64
    s_add_u32 s27, s27, 1024
    s_waitcnt vmcnt(6) lgkmcnt(6)
    v_mfma_f32_16x16x32_bf16 v[80:83], v[48:51], v[16:19], v[80:83]
    v_mfma_f32_16x16x32_bf16 v[84:87], v[48:51], v[20:23], v[84:87]
    v_mfma_f32_16x16x32_bf16 v[88:91], v[52:55], v[16:19], v[88:91]
    v_mfma_f32_16x16x32_bf16 v[92:95], v[52:55], v[20:23], v[92:95]
    buffer_load_dwordx4 v[48:51], v12, s[8:11], s27 offen
    buffer_load_dwordx4 v[52:55], v13, s[8:11], s27 offen
    ds_read_b128 v[16:19], v8
    v_add_u32 v8, 64, v8
    ds_read_b128 v[20:23], v9
    v_add_u32 v9, 64, v9
    s_add_u32 s26, s26, 64
    s_add_u32 s27, s27, 1024
    s_waitcnt vmcnt(6) lgkmcnt(6)
    v_mfma_f32_16x16x32_bf16 v[80:83], v[56:59], v[24:27], v[80:83]
    v_mfma_f32_16x16x32_bf16 v[84:87], v[56:59], v[28:31], v[84:87]
    v_mfma_f32_16x16x32_bf16 v[88:91], v[60:63], v[24:27], v[88:91]
    v_mfma_f32_16x16x32_bf16 v[92:95], v[60:63], v[28:31], v[92:95]
    buffer_load_dwordx4 v[56:59], v12, s[8:11], s27 offen
    buffer_load_dwordx4 v[60:63], v13, s[8:11], s27 offen
    ds_read_b128 v[24:27], v8
    v_add_u32 v8, 64, v8
    ds_read_b128 v[28:31], v9
    v_add_u32 v9, 64, v9
    s_add_u32 s26, s26, 64
    s_add_u32 s27, s27, 1024
    s_waitcnt vmcnt(6) lgkmcnt(6)
    v_mfma_f32_16x16x32_bf16 v[80:83], v[64:67], v[32:35], v[80:83]
    v_mfma_f32_16x16x32_bf16 v[84:87], v[64:67], v[36:39], v[84:87]
    v_mfma_f32_16x16x32_bf16 v[88:91], v[68:71], v[32:35], v[88:91]
    v_mfma_f32_16x16x32_bf16 v[92:95], v[68:71], v[36:39], v[92:95]
    buffer_load_dwordx4 v[64:67], v12, s[8:11], s27 offen
    buffer_load_dwordx4 v[68:71], v13, s[8:11], s27 offen
    ds_read_b128 v[32:35], v8
    v_add_u32 v8, 64, v8
    ds_read_b128 v[36:39], v9
    v_add_u32 v9, 64, v9
    s_add_u32 s26, s26, 64
    s_add_u32 s27, s27, 1024
    s_waitcnt vmcnt(6) lgkmcnt(6)
    v_mfma_f32_16x16x32_bf16 v[80:83], v[72:75], v[40:43], v[80:83]
    v_mfma_f32_16x16x32_bf16 v[84:87], v[72:75], v[44:47], v[84:87]
    v_mfma_f32_16x16x32_bf16 v[88:91], v[76:79], v[40:43], v[88:91]
    v_mfma_f32_16x16x32_bf16 v[92:95], v[76:79], v[44:47], v[92:95]
    s_sub_u32 s28, s28, 1
    s_cmp_lg_u32 s28, 0
    s_cbranch_scc1 .gl105
    s_waitcnt vmcnt(0) lgkmcnt(0)
    s_nop 7
    s_nop 7
    s_lshl_b32 s21, s44, 5
    v_add_u32 v4, s21, v2
    s_mov_b32 s25, 3584
    v_mul_lo_u32 v4, v4, s25
    s_lshl_b32 s25, s22, 5
    v_lshl_add_u32 v4, v3, 3, v4
    v_add_u32 v4, s25, v4
    v_add_u32 v4, 0x6400000, v4

    v_cvt_pk_bf16_f32 v20, v80, v81
    v_cvt_pk_bf16_f32 v21, v88, v89
    v_lshlrev_b32 v22, 16, v20
    v_and_b32 v23, 0xffff0000, v20
    v_lshlrev_b32 v24, 16, v21
    v_and_b32 v25, 0xffff0000, v21
    v_mul_f32 v22, v22, v24
    v_mul_f32 v23, v23, v25
    v_cvt_pk_bf16_f32 v16, v22, v23
    v_cvt_pk_bf16_f32 v20, v82, v83
    v_cvt_pk_bf16_f32 v21, v90, v91
    v_lshlrev_b32 v22, 16, v20
    v_and_b32 v23, 0xffff0000, v20
    v_lshlrev_b32 v24, 16, v21
    v_and_b32 v25, 0xffff0000, v21
    v_mul_f32 v22, v22, v24
    v_mul_f32 v23, v23, v25
    v_cvt_pk_bf16_f32 v17, v22, v23
    buffer_store_dwordx2 v[16:17], v4, s[8:11], 0 offen sc1
    v_add_u32 v4, 57344, v4
    v_cvt_pk_bf16_f32 v20, v84, v85
    v_cvt_pk_bf16_f32 v21, v92, v93
    v_lshlrev_b32 v22, 16, v20
    v_and_b32 v23, 0xffff0000, v20
    v_lshlrev_b32 v24, 16, v21
    v_and_b32 v25, 0xffff0000, v21
    v_mul_f32 v22, v22, v24
    v_mul_f32 v23, v23, v25
    v_cvt_pk_bf16_f32 v18, v22, v23
    v_cvt_pk_bf16_f32 v20, v86, v87
    v_cvt_pk_bf16_f32 v21, v94, v95
    v_lshlrev_b32 v22, 16, v20
    v_and_b32 v23, 0xffff0000, v20
    v_lshlrev_b32 v24, 16, v21
    v_and_b32 v25, 0xffff0000, v21
    v_mul_f32 v22, v22, v24
    v_mul_f32 v23, v23, v25
    v_cvt_pk_bf16_f32 v19, v22, v23
    buffer_store_dwordx2 v[18:19], v4, s[8:11], 0 offen sc1
    s_lshl_b32 s46, s44, 4
    s_add_u32 s46, s46, s45
    s_lshl_b32 s46, s46, 2
    s_add_u32 s46, s46, 0x7106400
    s_waitcnt vmcnt(0)
    s_barrier
    s_cmp_lg_u32 s20, 0
    s_cbranch_scc1 .sf106
    v_mov_b32 v4, s46
    v_mov_b32 v5, 1
    s_mov_b64 exec, 1
    buffer_store_dword v5, v4, s[8:11], 0 offen sc1
    s_mov_b64 exec, -1
.sf106:
    s_branch .pn82
.pF281:
    s_lshl_b32 s21, s44, 4
    s_add_u32 s22, s21, s20
    s_lshl_b32 s22, s22, 2
    s_add_u32 s22, s22, 0x7106400

    v_mov_b32 v16, s22
    s_mov_b32 s37, 0
.wf107:
    buffer_load_dword v17, v16, s[8:11], 0 offen sc1
    s_waitcnt vmcnt(0)
    v_readfirstlane_b32 s38, v17
    s_add_u32 s37, s37, 1
    s_cmp_lg_u32 s38, 0
    s_cbranch_scc1 .wfd108
    s_sleep 2
    s_cmp_lt_u32 s37, 1048576
    s_cbranch_scc1 .wf107
.wfd108:
    s_add_u32 s22, s22, 32
    s_add_u32 s21, s21, s45
    s_lshl_b32 s21, s21, 2
    s_add_u32 s21, s21, 0x7104400
    s_cmp_lt_u32 s20, 6
    s_cselect_b32 s21, s22, s21

    v_mov_b32 v16, s21
    s_mov_b32 s37, 0
.wf109:
    buffer_load_dword v17, v16, s[8:11], 0 offen sc1
    s_waitcnt vmcnt(0)
    v_readfirstlane_b32 s38, v17
    s_add_u32 s37, s37, 1
    s_cmp_lg_u32 s38, 0
    s_cbranch_scc1 .wfd110
    s_sleep 2
    s_cmp_lt_u32 s37, 1048576
    s_cbranch_scc1 .wf109
.wfd110:
    s_barrier
    s_lshl_b32 s21, s44, 5
    s_lshl_b32 s22, s45, 1
    v_add_u32 v4, s21, v2
    s_mov_b32 s23, 3584
    v_mul_lo_u32 v4, v4, s23
    v_lshl_add_u32 v4, v3, 4, v4
    v_add_u32 v4, 0x6400000, v4

    v_add_u32 v8, 0, v4
    v_add_u32 v9, 57344, v4
    s_mul_i32 s25, s22, 1024
    s_add_u32 s25, s25, 0x1600000
    v_lshl_add_u32 v4, v1, 4, s25
    v_add_u32 v12, 0, v4
    v_add_u32 v13, 1024, v4
    s_mul_i32 s26, s20, 512
    s_mul_i32 s27, s20, 262144
    s_cmp_ge_u32 s20, 7
    s_cbranch_scc1 .skz111
    v_mov_b32 v80, 0
    v_mov_b32 v81, 0
    v_mov_b32 v82, 0
    v_mov_b32 v83, 0
    v_mov_b32 v84, 0
    v_mov_b32 v85, 0
    v_mov_b32 v86, 0
    v_mov_b32 v87, 0
    v_mov_b32 v88, 0
    v_mov_b32 v89, 0
    v_mov_b32 v90, 0
    v_mov_b32 v91, 0
    v_mov_b32 v92, 0
    v_mov_b32 v93, 0
    v_mov_b32 v94, 0
    v_mov_b32 v95, 0
    buffer_load_dwordx4 v[48:51], v12, s[8:11], s27 offen
    buffer_load_dwordx4 v[52:55], v13, s[8:11], s27 offen
    buffer_load_dwordx4 v[16:19], v8, s[8:11], s26 offen sc1
    buffer_load_dwordx4 v[20:23], v9, s[8:11], s26 offen sc1
    s_add_u32 s26, s26, 64
    s_add_u32 s27, s27, 32768
    buffer_load_dwordx4 v[56:59], v12, s[8:11], s27 offen
    buffer_load_dwordx4 v[60:63], v13, s[8:11], s27 offen
    buffer_load_dwordx4 v[24:27], v8, s[8:11], s26 offen sc1
    buffer_load_dwordx4 v[28:31], v9, s[8:11], s26 offen sc1
    s_add_u32 s26, s26, 64
    s_add_u32 s27, s27, 32768
    buffer_load_dwordx4 v[64:67], v12, s[8:11], s27 offen
    buffer_load_dwordx4 v[68:71], v13, s[8:11], s27 offen
    buffer_load_dwordx4 v[32:35], v8, s[8:11], s26 offen sc1
    buffer_load_dwordx4 v[36:39], v9, s[8:11], s26 offen sc1
    s_add_u32 s26, s26, 64
    s_add_u32 s27, s27, 32768
    s_mov_b32 s28, 2
.gl113:
    buffer_load_dwordx4 v[72:75], v12, s[8:11], s27 offen
    buffer_load_dwordx4 v[76:79], v13, s[8:11], s27 offen
    buffer_load_dwordx4 v[40:43], v8, s[8:11], s26 offen sc1
    buffer_load_dwordx4 v[44:47], v9, s[8:11], s26 offen sc1
    s_add_u32 s26, s26, 64
    s_add_u32 s27, s27, 32768
    s_waitcnt vmcnt(12)
    v_mfma_f32_16x16x32_bf16 v[80:83], v[48:51], v[16:19], v[80:83]
    v_mfma_f32_16x16x32_bf16 v[84:87], v[48:51], v[20:23], v[84:87]
    v_mfma_f32_16x16x32_bf16 v[88:91], v[52:55], v[16:19], v[88:91]
    v_mfma_f32_16x16x32_bf16 v[92:95], v[52:55], v[20:23], v[92:95]
    buffer_load_dwordx4 v[48:51], v12, s[8:11], s27 offen
    buffer_load_dwordx4 v[52:55], v13, s[8:11], s27 offen
    buffer_load_dwordx4 v[16:19], v8, s[8:11], s26 offen sc1
    buffer_load_dwordx4 v[20:23], v9, s[8:11], s26 offen sc1
    s_add_u32 s26, s26, 64
    s_add_u32 s27, s27, 32768
    s_waitcnt vmcnt(12)
    v_mfma_f32_16x16x32_bf16 v[80:83], v[56:59], v[24:27], v[80:83]
    v_mfma_f32_16x16x32_bf16 v[84:87], v[56:59], v[28:31], v[84:87]
    v_mfma_f32_16x16x32_bf16 v[88:91], v[60:63], v[24:27], v[88:91]
    v_mfma_f32_16x16x32_bf16 v[92:95], v[60:63], v[28:31], v[92:95]
    buffer_load_dwordx4 v[56:59], v12, s[8:11], s27 offen
    buffer_load_dwordx4 v[60:63], v13, s[8:11], s27 offen
    buffer_load_dwordx4 v[24:27], v8, s[8:11], s26 offen sc1
    buffer_load_dwordx4 v[28:31], v9, s[8:11], s26 offen sc1
    s_add_u32 s26, s26, 64
    s_add_u32 s27, s27, 32768
    s_waitcnt vmcnt(12)
    v_mfma_f32_16x16x32_bf16 v[80:83], v[64:67], v[32:35], v[80:83]
    v_mfma_f32_16x16x32_bf16 v[84:87], v[64:67], v[36:39], v[84:87]
    v_mfma_f32_16x16x32_bf16 v[88:91], v[68:71], v[32:35], v[88:91]
    v_mfma_f32_16x16x32_bf16 v[92:95], v[68:71], v[36:39], v[92:95]
    buffer_load_dwordx4 v[64:67], v12, s[8:11], s27 offen
    buffer_load_dwordx4 v[68:71], v13, s[8:11], s27 offen
    buffer_load_dwordx4 v[32:35], v8, s[8:11], s26 offen sc1
    buffer_load_dwordx4 v[36:39], v9, s[8:11], s26 offen sc1
    s_add_u32 s26, s26, 64
    s_add_u32 s27, s27, 32768
    s_waitcnt vmcnt(12)
    v_mfma_f32_16x16x32_bf16 v[80:83], v[72:75], v[40:43], v[80:83]
    v_mfma_f32_16x16x32_bf16 v[84:87], v[72:75], v[44:47], v[84:87]
    v_mfma_f32_16x16x32_bf16 v[88:91], v[76:79], v[40:43], v[88:91]
    v_mfma_f32_16x16x32_bf16 v[92:95], v[76:79], v[44:47], v[92:95]
    s_sub_u32 s28, s28, 1
    s_cmp_lg_u32 s28, 0
    s_cbranch_scc1 .gl113
    s_waitcnt vmcnt(0) lgkmcnt(0)
    s_nop 7
    s_nop 7
    s_branch .skr112
.skz111:
    v_mov_b32 v80, 0
    v_mov_b32 v81, 0
    v_mov_b32 v82, 0
    v_mov_b32 v83, 0
    v_mov_b32 v84, 0
    v_mov_b32 v85, 0
    v_mov_b32 v86, 0
    v_mov_b32 v87, 0
    v_mov_b32 v88, 0
    v_mov_b32 v89, 0
    v_mov_b32 v90, 0
    v_mov_b32 v91, 0
    v_mov_b32 v92, 0
    v_mov_b32 v93, 0
    v_mov_b32 v94, 0
    v_mov_b32 v95, 0
.skr112:
    s_lshl_b32 s25, s20, 12
    v_lshl_add_u32 v4, v1, 4, s25
    ds_write_b128 v4, v[80:83] offset:0
    ds_write_b128 v4, v[84:87] offset:1024
    ds_write_b128 v4, v[88:91] offset:2048
    ds_write_b128 v4, v[92:95] offset:3072
    s_waitcnt lgkmcnt(0)
    s_barrier
    s_cmp_ge_u32 s20, 4
    s_cbranch_scc1 .sks114
    s_lshl_b32 s25, s20, 10
    v_lshl_add_u32 v4, v1, 4, s25
    ds_read_b128 v[16:19], v4 offset:0
    ds_read_b128 v[20:23], v4 offset:4096
    ds_read_b128 v[24:27], v4 offset:8192
    ds_read_b128 v[28:31], v4 offset:12288
    ds_read_b128 v[32:35], v4 offset:16384
    ds_read_b128 v[36:39], v4 offset:20480
    ds_read_b128 v[40:43], v4 offset:24576
    ds_read_b128 v[44:47], v4 offset:28672
    s_and_b32 s25, s20, 1
    s_lshl_b32 s25, s25, 4
    s_add_u32 s25, s25, s21
    v_add_u32 v5, s25, v2
    v_lshlrev_b32 v5, 10, v5
    s_lshr_b32 s25, s20, 1
    s_add_u32 s25, s25, s22
    s_lshl_b32 s25, s25, 5
    v_lshl_add_u32 v5, v3, 3, v5
    v_add_u32 v5, s25, v5
    v_add_u32 v6, 0x6000000, v5

    buffer_load_dwordx2 v[96:97], v6, s[8:11], 0 offen sc1
    s_waitcnt vmcnt(0) lgkmcnt(0)
    v_add_f32 v16, v16, v20
    v_add_f32 v16, v16, v24
    v_add_f32 v16, v16, v28
    v_add_f32 v16, v16, v32
    v_add_f32 v16, v16, v36
    v_add_f32 v16, v16, v40
    v_add_f32 v16, v16, v44
    v_add_f32 v17, v17, v21
    v_add_f32 v17, v17, v25
    v_add_f32 v17, v17, v29
    v_add_f32 v17, v17, v33
    v_add_f32 v17, v17, v37
    v_add_f32 v17, v17, v41
    v_add_f32 v17, v17, v45
    v_add_f32 v18, v18, v22
    v_add_f32 v18, v18, v26
    v_add_f32 v18, v18, v30
    v_add_f32 v18, v18, v34
    v_add_f32 v18, v18, v38
    v_add_f32 v18, v18, v42
    v_add_f32 v18, v18, v46
    v_add_f32 v19, v19, v23
    v_add_f32 v19, v19, v27
    v_add_f32 v19, v19, v31
    v_add_f32 v19, v19, v35
    v_add_f32 v19, v19, v39
    v_add_f32 v19, v19, v43
    v_add_f32 v19, v19, v47
    v_cvt_pk_bf16_f32 v90, v16, v17
    v_cvt_pk_bf16_f32 v91, v18, v19
    v_lshlrev_b32 v92, 16, v90
    v_and_b32 v93, 0xffff0000, v90
    v_lshlrev_b32 v94, 16, v96
    v_and_b32 v95, 0xffff0000, v96
    v_add_f32 v92, v92, v94
    v_add_f32 v93, v93, v95
    v_cvt_pk_bf16_f32 v100, v92, v93
    v_lshlrev_b32 v92, 16, v91
    v_and_b32 v93, 0xffff0000, v91
    v_lshlrev_b32 v94, 16, v97
    v_and_b32 v95, 0xffff0000, v97
    v_add_f32 v92, v92, v94
    v_add_f32 v93, v93, v95
    v_cvt_pk_bf16_f32 v101, v92, v93
    buffer_store_dwordx2 v[100:101], v5, s[16:19], 0 offen
.sks114:
    s_barrier
.pn82:
    s_add_u32 s43, s43, s42
    s_branch .pt77
.mend12:
.mexit14:
    s_endpgm
.section .rodata,"a"
.p2align 6
.amdhsa_kernel prep_kernel
  .amdhsa_next_free_vgpr 48
  .amdhsa_next_free_sgpr 102
  .amdhsa_accum_offset 48
  .amdhsa_group_segment_fixed_size 0
  .amdhsa_kernarg_size 112
  .amdhsa_user_sgpr_count 2
  .amdhsa_user_sgpr_kernarg_segment_ptr 1
  .amdhsa_system_sgpr_workgroup_id_x 1
.end_amdhsa_kernel
.p2align 6
.amdhsa_kernel mega_kernel
  .amdhsa_next_free_vgpr 256
  .amdhsa_next_free_sgpr 102
  .amdhsa_accum_offset 256
  .amdhsa_group_segment_fixed_size 0
  .amdhsa_kernarg_size 112
  .amdhsa_user_sgpr_count 2
  .amdhsa_user_sgpr_kernarg_segment_ptr 1
  .amdhsa_system_sgpr_workgroup_id_x 1
.end_amdhsa_kernel
```
